```python
import torch

def _softmax(x, axis=-1):
    return torch.softmax(x, dim=axis)

def _gelu(x):
    return torch.nn.functional.gelu(x, approximate='tanh')

def _silu(x):
    return torch.nn.functional.silu(x)

def _sigmoid(x):
    return torch.sigmoid(x)

def _layernorm(x, axis=-1, eps=1e-05):
    m = x.mean(dim=axis, keepdim=True)
    v = x.var(dim=axis, keepdim=True, unbiased=False)
    return (x - m) / torch.sqrt(v + eps)

def _scatter_add(tgt, idx, src, axis=0):
    return tgt.clone().index_add_(axis, idx, src)

def _segment_sum(src, seg, n):
    out = torch.zeros((n,) + src.shape[1:], dtype=src.dtype)
    return out.index_add_(0, seg, src)

def _pad(x, pw):
    flat = tuple((v for pair in reversed(pw) for v in pair))
    return torch.nn.functional.pad(x, flat)
kernel_name = 'standalone__conformer_family_zipformer__speech'

def setup_inputs():

    _w = lambda a: (lambda t: t.to(torch.bfloat16) if t.is_floating_point() else t)(torch.as_tensor(a))
    B, T, D, K, H = (2, 1000, 256, 31, 4)
    sc = 0.1
    return {'x': _w((lambda *s: torch.randn(*s, dtype=torch.bfloat16) * 0.8)(B, T, D)), 'w_ff1a': _w((lambda *s: torch.randn(*s, dtype=torch.bfloat16) * 0.8)(D, 4 * D) * sc), 'w_ff1b': _w((lambda *s: torch.randn(*s, dtype=torch.bfloat16) * 0.8)(4 * D, D) * sc), 'w_qkv': _w((lambda *s: torch.randn(*s, dtype=torch.bfloat16) * 0.8)(D, 3 * D) * sc), 'w_o': _w((lambda *s: torch.randn(*s, dtype=torch.bfloat16) * 1.6)(D, D) * sc), 'w_pw1': _w((lambda *s: torch.randn(*s, dtype=torch.bfloat16) * 1.6)(D, 2 * D) * sc), 'dw': _w((lambda *s: torch.randn(*s, dtype=torch.bfloat16) * 0.4)(K, D)), 'w_pw2': _w((lambda *s: torch.randn(*s, dtype=torch.bfloat16) * 0.4)(D, D) * sc), 'w_ff2a': _w((lambda *s: torch.randn(*s, dtype=torch.bfloat16) * 0.8)(D, 4 * D) * sc), 'w_ff2b': _w((lambda *s: torch.randn(*s, dtype=torch.bfloat16) * 0.8)(4 * D, D) * sc)}

def reference(x, w_ff1a, w_ff1b, w_qkv, w_o, w_pw1, dw, w_pw2, w_ff2a, w_ff2b):
    B, T, D = x.shape
    K = dw.shape[0]
    H = 4
    Dh = D // H
    h = _layernorm(x, axis=-1)
    h = _silu(h @ w_ff1a) @ w_ff1b
    x = x + 0.5 * h
    h = _layernorm(x, axis=-1)
    qkv = h @ w_qkv
    q = (lambda x, *d: x.permute(*d))(qkv[..., :D].reshape(B, T, H, Dh), 0, 2, 1, 3)
    k = (lambda x, *d: x.permute(*d))(qkv[..., D:2 * D].reshape(B, T, H, Dh), 0, 2, 1, 3)
    v = (lambda x, *d: x.permute(*d))(qkv[..., 2 * D:].reshape(B, T, H, Dh), 0, 2, 1, 3)
    scale = Dh ** (-0.5)
    scores = torch.einsum('bhqd,bhkd->bhqk', q, k) * scale
    p = _softmax(scores, axis=-1)
    att = torch.einsum('bhqk,bhkd->bhqd', p, v)
    att = (lambda x, *d: x.permute(*d))(att, 0, 2, 1, 3).reshape(B, T, D)
    x = x + att @ w_o
    h = _layernorm(x, axis=-1)
    h = h @ w_pw1
    a, b = (h[..., :D].clone(), h[..., D:].clone())
    h = a * _sigmoid(b)
    pad = K // 2
    hp = _pad(h, ((0, 0), (pad, pad), (0, 0)))
    c = torch.zeros_like(h)
    for i in range(K):
        c = c + hp[:, i:i + T, :] * dw[i][None, None, :]
    x = x + _silu(c) @ w_pw2
    h = _layernorm(x, axis=-1)
    h = _silu(h @ w_ff2a) @ w_ff2b
    x = x + 0.5 * h
    return _layernorm(x, axis=-1)
```

```asm
; @launch grid=(256,1,1) block=(512,1,1) lds=163840
.amdgcn_target "amdgcn-amd-amdhsa--gfx950"
.text
.globl standalone__conformer_family_zipformer__speech_kernel
.p2align 8
.type standalone__conformer_family_zipformer__speech_kernel,@function
standalone__conformer_family_zipformer__speech_kernel:
    s_load_dwordx16 s[8:23], s[0:1], 0
    s_load_dwordx8 s[24:31], s[0:1], 64
    s_load_dwordx2 s[32:33], s[0:1], 96
    s_cmp_ge_u32 s2, 256
    s_cbranch_scc1 L_end
    s_and_b32 s5, s2, 7
    s_lshl_b32 s5, s5, 5
    s_lshr_b32 s61, s2, 3
    s_or_b32 s5, s5, s61
    s_and_b32 s56, s5, 3
    s_lshr_b32 s57, s5, 2
    s_lshr_b32 s58, s5, 7
    s_and_b32 s59, s57, 31
    v_lshrrev_b32 v14, 6, v0
    v_and_b32 v1, 63, v0
    v_readfirstlane_b32 s60, v14
    v_lshlrev_b32 v2, 4, v1
    v_and_b32 v13, 31, v1
    v_lshlrev_b32 v13, 9, v13
    v_lshl_or_b32 v13, v14, 6, v13
    v_lshrrev_b32 v15, 5, v1
    v_lshl_or_b32 v11, v15, 4, v13
    v_and_b32 v13, 7, v1
    v_bfe_u32 v14, v1, 4, 1
    v_lshlrev_b32 v15, 2, v14
    v_xor_b32 v13, v13, v15
    v_lshlrev_b32 v6, 4, v13
    s_lshl_b32 s72, s60, 13
    s_lshl_b32 s73, s60, 10
    s_lshr_b32 s63, s60, 1
    s_and_b32 s3, s60, 1
    s_lshl_b32 s68, s63, 7
    s_lshl_b32 s61, s3, 17
    s_add_u32 s74, s68, s61
    s_lshl_b32 s61, s56, 9
    s_add_u32 s74, s74, s61
    s_lshl_b32 s61, s3, 15
    s_add_u32 s70, s68, s61
    s_lshl_b32 s61, s56, 17
    s_add_u32 s70, s70, s61
    s_lshl_b32 s71, s63, 9
    s_mul_i32 s61, s3, 98304
    s_add_u32 s71, s71, s61
    s_lshl_b32 s61, s56, 7
    s_add_u32 s71, s71, s61
    s_cmp_ge_u32 s60, 6
    s_cselect_b32 s71, 0x70000000, s71
    s_mul_i32 s63, s58, 512000
    s_waitcnt lgkmcnt(0)
    s_add_u32 s36, s8, s63
    s_addc_u32 s37, s9, 0
    s_mov_b32 s38, 512000
    s_mov_b32 s39, 0x20000
    s_lshl_b32 s3, s59, 14
    buffer_load_dwordx4 v[32:35], v11, s[36:39], s3 offen offset:0
    buffer_load_dwordx4 v[36:39], v11, s[36:39], s3 offen offset:32
    s_mov_b32 s48, s10
    s_mov_b32 s49, s11
    s_mov_b32 s50, 524288
    s_mov_b32 s51, 0x20000
    s_and_b32 s61, s5, 31
    s_mul_i32 s61, s61, 16384
    v_lshlrev_b32 v12, 7, v0
    v_cmp_gt_u32 vcc, 16384, v12
    v_mov_b32 v13, 0x7ffffff0
    s_nop 0
    v_cndmask_b32 v12, v13, v12, vcc
    buffer_load_dword v250, v12, s[48:51], s61 offen
    s_mov_b32 s44, s30
    s_mov_b32 s45, s31
    s_mov_b32 s46, 256
    s_mov_b32 s47, 0x20000
    s_xor_b32 s3, s5, 40
    s_or_b32 s3, s3, s60
    s_cmp_lg_u32 s3, 0
    s_cbranch_scc1 L_1
    s_memrealtime s[34:35]
    s_waitcnt lgkmcnt(0)
    s_or_b32 s34, s34, 1
    v_mov_b32 v14, s34
    v_mov_b32 v15, 0
    s_mov_b64 exec, 1
    buffer_store_dword v14, v15, s[44:47], 0 offen sc1
    s_mov_b64 exec, -1
L_1:
    s_sub_u32 s84, s5, 32
    s_cmp_ge_u32 s84, 4
    s_cbranch_scc1 L_dwe
    s_cmp_lg_u32 s60, 6
    s_cbranch_scc1 L_dwe
    s_mov_b32 s88, s20
    s_mov_b32 s89, s21
    s_mov_b32 s90, 15872
    s_mov_b32 s91, 0x20000
    v_lshlrev_b32 v224, 1, v1
    s_lshl_b32 s85, s84, 7
    v_mov_b32 v223, 0
    buffer_load_ushort v192, v224, s[88:91], s85 offen offset:0
    buffer_load_ushort v193, v224, s[88:91], s85 offen offset:512
    buffer_load_ushort v194, v224, s[88:91], s85 offen offset:1024
    buffer_load_ushort v195, v224, s[88:91], s85 offen offset:1536
    buffer_load_ushort v196, v224, s[88:91], s85 offen offset:2048
    buffer_load_ushort v197, v224, s[88:91], s85 offen offset:2560
    buffer_load_ushort v198, v224, s[88:91], s85 offen offset:3072
    buffer_load_ushort v199, v224, s[88:91], s85 offen offset:3584
    s_add_u32 s85, s85, 4096
    buffer_load_ushort v200, v224, s[88:91], s85 offen offset:0
    buffer_load_ushort v201, v224, s[88:91], s85 offen offset:512
    buffer_load_ushort v202, v224, s[88:91], s85 offen offset:1024
    buffer_load_ushort v203, v224, s[88:91], s85 offen offset:1536
    buffer_load_ushort v204, v224, s[88:91], s85 offen offset:2048
    buffer_load_ushort v205, v224, s[88:91], s85 offen offset:2560
    buffer_load_ushort v206, v224, s[88:91], s85 offen offset:3072
    buffer_load_ushort v207, v224, s[88:91], s85 offen offset:3584
    s_add_u32 s85, s85, 4096
    buffer_load_ushort v208, v224, s[88:91], s85 offen offset:0
    buffer_load_ushort v209, v224, s[88:91], s85 offen offset:512
    buffer_load_ushort v210, v224, s[88:91], s85 offen offset:1024
    buffer_load_ushort v211, v224, s[88:91], s85 offen offset:1536
    buffer_load_ushort v212, v224, s[88:91], s85 offen offset:2048
    buffer_load_ushort v213, v224, s[88:91], s85 offen offset:2560
    buffer_load_ushort v214, v224, s[88:91], s85 offen offset:3072
    buffer_load_ushort v215, v224, s[88:91], s85 offen offset:3584
    s_add_u32 s85, s85, 4096
    buffer_load_ushort v216, v224, s[88:91], s85 offen offset:0
    buffer_load_ushort v217, v224, s[88:91], s85 offen offset:512
    buffer_load_ushort v218, v224, s[88:91], s85 offen offset:1024
    buffer_load_ushort v219, v224, s[88:91], s85 offen offset:1536
    buffer_load_ushort v220, v224, s[88:91], s85 offen offset:2048
    buffer_load_ushort v221, v224, s[88:91], s85 offen offset:2560
    buffer_load_ushort v222, v224, s[88:91], s85 offen offset:3072
L_dwe:
    s_nop 1
    s_mov_b32 s43, 0x20000
    s_mov_b32 s76, s12
    s_mov_b32 s77, s13
    s_mov_b32 s78, 524288
    s_mov_b32 s79, 0x20000
    buffer_load_dword v251, v12, s[76:79], s61 offen
    v_lshrrev_b32 v5, 3, v1
    v_mul_u32_u24 v5, 2048, v5
    v_add_u32 v5, v5, v6
    s_add_u32 m0, s72, 0
    s_add_u32 s75, s74, 0
    buffer_load_dwordx4 v5, s[48:51], s75 offen lds
    s_add_u32 m0, s72, 1024
    s_add_u32 s75, s74, 16384
    buffer_load_dwordx4 v5, s[48:51], s75 offen lds
    s_add_u32 m0, s72, 2048
    s_add_u32 s75, s74, 32768
    buffer_load_dwordx4 v5, s[48:51], s75 offen lds
    s_add_u32 m0, s72, 3072
    s_add_u32 s75, s74, 49152
    buffer_load_dwordx4 v5, s[48:51], s75 offen lds
    s_add_u32 m0, s72, 4096
    s_add_u32 s75, s74, 65536
    buffer_load_dwordx4 v5, s[48:51], s75 offen lds
    s_add_u32 m0, s72, 5120
    s_add_u32 s75, s74, 81920
    buffer_load_dwordx4 v5, s[48:51], s75 offen lds
    s_add_u32 m0, s72, 6144
    s_add_u32 s75, s74, 98304
    buffer_load_dwordx4 v5, s[48:51], s75 offen lds
    s_add_u32 m0, s72, 7168
    s_add_u32 s75, s74, 114688
    buffer_load_dwordx4 v5, s[48:51], s75 offen lds
    s_mov_b32 s44, s32
    s_mov_b32 s45, s33
    s_mov_b32 s46, 268435456
    s_mov_b32 s47, 0x20000
    s_getreg_b32 s64, hwreg(HW_REG_XCC_ID)
    s_and_b32 s64, s64, 15
    s_or_b32 s64, s64, 16
    v_lshrrev_b32 v15, 5, v1
    v_bfe_u32 v13, v1, 2, 2
    v_lshl_or_b32 v15, v15, 2, v13
    v_lshlrev_b32 v3, 7, v15
    v_and_b32 v14, 3, v1
    v_lshl_or_b32 v3, v14, 3, v3
    v_bfe_u32 v14, v1, 3, 1
    v_lshl_or_b32 v3, v14, 6, v3
    v_bfe_u32 v14, v1, 4, 1
    v_lshl_or_b32 v3, v14, 5, v3
    s_and_b32 s61, s60, 1
    s_lshl_b32 s61, s61, 6
    s_lshr_b32 s62, s60, 1
    s_lshl_b32 s62, s62, 14
    v_xor_b32 v3, s61, v3
    v_add_u32 v3, s62, v3
    v_add_u32 v4, 0x10000, v3
    v_add_u32 v8, 131072, v2
    s_lshl_b32 s61, s60, 11
    v_add_u32 v7, s61, v8
    s_lshl_b32 s66, s5, 14
    s_add_u32 s66, s66, s61
    s_lshl_b32 s67, s5, 12
    s_add_u32 s67, s67, s73
    v_lshlrev_b32 v10, 2, v1
    v_add_u32 v10, 147456, v10
    s_lshl_b32 s61, s60, 8
    v_add_u32 v9, s61, v10
    v_mov_b32 v56, -1
    v_mov_b32 v57, -1
    v_mov_b32 v58, -1
    v_mov_b32 v59, -1
    buffer_store_dwordx4 v[56:59], v2, s[44:47], s66 offen offset:0
    buffer_store_dwordx4 v[56:59], v2, s[44:47], s66 offen offset:1024
    v_lshrrev_b32 v5, 3, v1
    v_mul_u32_u24 v5, 2048, v5
    v_add_u32 v5, v5, v6
    s_lshl_b32 s61, s58, 2
    s_add_u32 s61, s61, s56
    s_lshl_b32 s61, s61, 18
    s_add_u32 s61, s61, 4194304
    s_lshl_b32 s62, s60, 15
    s_add_u32 s68, s61, s62
    s_lshl_b32 s62, s59, 13
    s_add_u32 s69, s61, s62
    v_and_b32 v188, 31, v1
    v_lshlrev_b32 v188, 1, v188
    s_lshl_b32 s62, s5, 1
    s_and_b32 s3, s60, 1
    s_add_u32 s62, s62, s3
    s_cmp_ge_u32 s60, 4
    s_cselect_b32 s62, s5, s62
    s_lshl_b32 s34, s62, 10
    s_and_b32 s3, s62, 15
    s_lshr_b32 s35, s62, 4
    s_movk_i32 s54, 512
    s_and_b32 s53, s35, 7
    s_lshl_b32 s53, s53, 6
    s_cmp_ge_u32 s5, 128
    s_cselect_b32 s40, s22, s16
    s_cselect_b32 s41, s23, s17
    s_lshr_b32 s35, s35, 3
    s_lshl_b32 s35, s35, 17
    s_cmp_ge_u32 s60, 4
    s_cselect_b32 s40, s40, s26
    s_cselect_b32 s41, s41, s27
    s_cselect_b32 s35, 0, s35
    s_cselect_b32 s61, -262144, 0
    s_add_u32 s53, s53, s35
    s_add_u32 s34, s34, s61
    s_add_u32 s34, s34, 9699328
    s_lshr_b32 s61, 0x2c, s60
    s_and_b32 s61, s61, 1
    s_cselect_b32 s34, s34, 0x70000000
    s_lshl_b32 s42, s61, 19
    s_mul_i32 s3, s3, s54
    s_lshl_b32 s3, s3, 4
    s_add_u32 s53, s53, s3
    v_lshrrev_b32 v13, 5, v1
    s_lshl_b32 s55, s54, 2
    v_mad_u32_u24 v188, v13, s55, v188
    s_waitcnt vmcnt(12)
    v_permlane32_swap_b32 v32, v34
    s_add_u32 m0, s72, 65536
    s_add_u32 s75, s74, 262144
    buffer_load_dwordx4 v5, s[48:51], s75 offen lds
    v_permlane32_swap_b32 v33, v35
    v_permlane32_swap_b32 v36, v38
    v_permlane32_swap_b32 v37, v39
    v_lshlrev_b32 v16, 16, v32
    v_and_b32 v17, 0xffff0000, v32
    v_lshlrev_b32 v18, 16, v33
    v_and_b32 v19, 0xffff0000, v33
    v_lshlrev_b32 v20, 16, v34
    v_and_b32 v21, 0xffff0000, v34
    s_add_u32 m0, s72, 66560
    s_add_u32 s75, s74, 278528
    buffer_load_dwordx4 v5, s[48:51], s75 offen lds
    v_lshlrev_b32 v22, 16, v35
    v_and_b32 v23, 0xffff0000, v35
    v_lshlrev_b32 v24, 16, v36
    v_and_b32 v25, 0xffff0000, v36
    v_lshlrev_b32 v26, 16, v37
    v_and_b32 v27, 0xffff0000, v37
    v_lshlrev_b32 v28, 16, v38
    v_and_b32 v29, 0xffff0000, v38
    v_lshlrev_b32 v30, 16, v39
    s_add_u32 m0, s72, 67584
    s_add_u32 s75, s74, 294912
    buffer_load_dwordx4 v5, s[48:51], s75 offen lds
    v_and_b32 v31, 0xffff0000, v39
    v_pk_mul_f32 v[48:49], v[16:17], v[16:17]
    v_pk_add_f32 v[50:51], v[16:17], v[18:19]
    v_pk_fma_f32 v[48:49], v[18:19], v[18:19], v[48:49]
    v_pk_fma_f32 v[48:49], v[20:21], v[20:21], v[48:49]
    v_pk_fma_f32 v[48:49], v[22:23], v[22:23], v[48:49]
    v_pk_fma_f32 v[48:49], v[24:25], v[24:25], v[48:49]
    v_pk_fma_f32 v[48:49], v[26:27], v[26:27], v[48:49]
    v_pk_fma_f32 v[48:49], v[28:29], v[28:29], v[48:49]
    s_add_u32 m0, s72, 68608
    s_add_u32 s75, s74, 311296
    buffer_load_dwordx4 v5, s[48:51], s75 offen lds
    v_pk_fma_f32 v[48:49], v[30:31], v[30:31], v[48:49]
    v_pk_add_f32 v[50:51], v[50:51], v[20:21]
    v_pk_add_f32 v[50:51], v[50:51], v[22:23]
    v_pk_add_f32 v[50:51], v[50:51], v[24:25]
    v_pk_add_f32 v[50:51], v[50:51], v[26:27]
    v_pk_add_f32 v[50:51], v[50:51], v[28:29]
    v_pk_add_f32 v[50:51], v[50:51], v[30:31]
    v_add_f32 v13, v48, v49
    v_add_f32 v12, v50, v51
    s_add_u32 m0, s72, 69632
    s_add_u32 s75, s74, 327680
    buffer_load_dwordx4 v5, s[48:51], s75 offen lds
    v_permlane32_swap_b32 v12, v13
    v_add_f32 v12, v12, v13
    ds_write_b32 v9, v12
    s_waitcnt lgkmcnt(0)
    s_barrier
    ds_read2st64_b32 v[48:49], v10 offset0:0 offset1:1
    ds_read2st64_b32 v[50:51], v10 offset0:2 offset1:3
    ds_read2st64_b32 v[52:53], v10 offset0:4 offset1:5
    ds_read2st64_b32 v[54:55], v10 offset0:6 offset1:7
    s_waitcnt lgkmcnt(0)
    v_pk_add_f32 v[48:49], v[48:49], v[50:51]
    s_add_u32 m0, s72, 70656
    s_add_u32 s75, s74, 344064
    buffer_load_dwordx4 v5, s[48:51], s75 offen lds
    v_pk_add_f32 v[52:53], v[52:53], v[54:55]
    v_pk_add_f32 v[48:49], v[48:49], v[52:53]
    v_add_f32 v12, v48, v49
    v_mul_f32 v12, 0x3b800000, v12
    v_mov_b32 v13, v12
    s_nop 1
    v_permlane32_swap_b32 v12, v13
    v_fma_f32 v13, -v12, v12, v13
    v_max_f32 v13, 0, v13
    v_add_f32 v13, 0x3727c5ac, v13
    s_add_u32 m0, s72, 71680
    s_add_u32 s75, s74, 360448
    buffer_load_dwordx4 v5, s[48:51], s75 offen lds
    v_rsq_f32 v14, v13
    s_nop 0
    v_mul_f32_e64 v15, -v12, v14
    v_pk_fma_f32 v[48:49], v[16:17], v[14:15], v[14:15] op_sel:[0,0,1] op_sel_hi:[1,0,1]
    v_pk_fma_f32 v[50:51], v[18:19], v[14:15], v[14:15] op_sel:[0,0,1] op_sel_hi:[1,0,1]
    v_pk_fma_f32 v[52:53], v[20:21], v[14:15], v[14:15] op_sel:[0,0,1] op_sel_hi:[1,0,1]
    v_pk_fma_f32 v[54:55], v[22:23], v[14:15], v[14:15] op_sel:[0,0,1] op_sel_hi:[1,0,1]
    v_pk_fma_f32 v[56:57], v[24:25], v[14:15], v[14:15] op_sel:[0,0,1] op_sel_hi:[1,0,1]
    v_pk_fma_f32 v[58:59], v[26:27], v[14:15], v[14:15] op_sel:[0,0,1] op_sel_hi:[1,0,1]
    s_add_u32 m0, s72, 72704
    s_add_u32 s75, s74, 376832
    buffer_load_dwordx4 v5, s[48:51], s75 offen lds
    v_pk_fma_f32 v[60:61], v[28:29], v[14:15], v[14:15] op_sel:[0,0,1] op_sel_hi:[1,0,1]
    v_pk_fma_f32 v[62:63], v[30:31], v[14:15], v[14:15] op_sel:[0,0,1] op_sel_hi:[1,0,1]
    v_cvt_pk_bf16_f32 v48, v48, v49
    v_cvt_pk_bf16_f32 v49, v50, v51
    v_cvt_pk_bf16_f32 v50, v52, v53
    v_cvt_pk_bf16_f32 v51, v54, v55
    v_cvt_pk_bf16_f32 v52, v56, v57
    v_cvt_pk_bf16_f32 v53, v58, v59
    v_cvt_pk_bf16_f32 v54, v60, v61
    v_cvt_pk_bf16_f32 v55, v62, v63
    ds_write_b128 v7, v[48:51]
    ds_write_b128 v7, v[52:55] offset:1024
    s_mov_b32 s48, s14
    s_mov_b32 s49, s15
    s_mov_b32 s50, 393216
    s_mov_b32 s51, 0x20000
    s_waitcnt vmcnt(10)
    s_waitcnt lgkmcnt(0)
    s_barrier
    ds_read_b128 v[64:67], v8 offset:0
    ds_read_b64_tr_b16 v[68:69], v3 offset:0
    ds_read_b64_tr_b16 v[70:71], v3 offset:1024
    ds_read_b128 v[72:75], v8 offset:1024
    ds_read_b64_tr_b16 v[76:77], v3 offset:2048
    ds_read_b64_tr_b16 v[78:79], v3 offset:3072
    ds_read_b128 v[80:83], v8 offset:2048
    ds_read_b64_tr_b16 v[84:85], v3 offset:4096
    ds_read_b64_tr_b16 v[86:87], v3 offset:5120
    ds_read_b128 v[88:91], v8 offset:3072
    ds_read_b64_tr_b16 v[92:93], v3 offset:6144
    ds_read_b64_tr_b16 v[94:95], v3 offset:7168
    ds_read_b128 v[96:99], v8 offset:4096
    ds_read_b64_tr_b16 v[100:101], v3 offset:8192
    ds_read_b64_tr_b16 v[102:103], v3 offset:9216
    s_waitcnt lgkmcnt(12)
    v_mfma_f32_32x32x16_bf16 v[32:47], v[68:71], v[64:67], 0
    ds_read_b128 v[104:107], v8 offset:5120
    ds_read_b64_tr_b16 v[108:109], v3 offset:10240
    ds_read_b64_tr_b16 v[110:111], v3 offset:11264
    buffer_load_ushort v144, v188, s[40:43], s53 offen
    s_add_u32 s53, s53, s54
    buffer_load_ushort v145, v188, s[40:43], s53 offen
    s_add_u32 s53, s53, s54
    s_waitcnt lgkmcnt(12)
    v_mfma_f32_32x32x16_bf16 v[32:47], v[76:79], v[72:75], v[32:47]
    ds_read_b128 v[64:67], v8 offset:6144
    ds_read_b64_tr_b16 v[68:69], v3 offset:12288
    ds_read_b64_tr_b16 v[70:71], v3 offset:13312
    buffer_load_ushort v146, v188, s[40:43], s53 offen
    s_add_u32 s53, s53, s54
    buffer_load_ushort v147, v188, s[40:43], s53 offen
    s_add_u32 s53, s53, s54
    s_add_u32 s53, s53, s55
    s_waitcnt lgkmcnt(12)
    v_mfma_f32_32x32x16_bf16 v[32:47], v[84:87], v[80:83], v[32:47]
    ds_read_b128 v[72:75], v8 offset:7168
    ds_read_b64_tr_b16 v[76:77], v3 offset:14336
    ds_read_b64_tr_b16 v[78:79], v3 offset:15360
    buffer_load_ushort v148, v188, s[40:43], s53 offen
    s_add_u32 s53, s53, s54
    s_waitcnt lgkmcnt(12)
    v_mfma_f32_32x32x16_bf16 v[32:47], v[92:95], v[88:91], v[32:47]
    buffer_load_ushort v149, v188, s[40:43], s53 offen
    s_add_u32 s53, s53, s54
    s_waitcnt lgkmcnt(9)
    v_mfma_f32_32x32x16_bf16 v[32:47], v[100:103], v[96:99], v[32:47]
    buffer_load_ushort v150, v188, s[40:43], s53 offen
    s_add_u32 s53, s53, s54
    s_waitcnt lgkmcnt(6)
    v_mfma_f32_32x32x16_bf16 v[32:47], v[108:111], v[104:107], v[32:47]
    buffer_load_ushort v151, v188, s[40:43], s53 offen
    s_waitcnt lgkmcnt(3)
    v_mfma_f32_32x32x16_bf16 v[32:47], v[68:71], v[64:67], v[32:47]
    v_mov_b32 v184, -1
    v_mov_b32 v185, -1
    v_mov_b32 v186, -1
    v_mov_b32 v187, -1
    s_lshr_b32 s61, s60, 2
    s_mul_i32 s61, s61, 2093056
    s_add_u32 s61, s61, s67
    s_add_u32 s61, s61, 6291456
    buffer_store_dwordx4 v[184:187], v2, s[44:47], s61 offen
    s_waitcnt lgkmcnt(0)
    v_mfma_f32_32x32x16_bf16 v[32:47], v[76:79], v[72:75], v[32:47]
    s_and_b32 s61, s5, 31
    s_mul_i32 s61, s61, 12288
    v_lshlrev_b32 v12, 7, v0
    v_cmp_gt_u32 vcc, 12288, v12
    v_mov_b32 v13, 0x7ffffff0
    s_nop 0
    v_cndmask_b32 v12, v13, v12, vcc
    buffer_load_dword v252, v12, s[48:51], s61 offen
    s_cmp_lg_u32 s60, 7
    s_cbranch_scc1 L_6
    s_mov_b32 s36, s30
    s_mov_b32 s37, s31
    s_mov_b32 s38, 256
    s_mov_b32 s39, 0x20000
    v_mov_b32 v13, 0
    s_movk_i32 s4, 0x4000
    s_nop 1
P_7:
    buffer_load_dword v14, v13, s[36:39], 0 offen sc1
    s_waitcnt vmcnt(0)
    v_cmp_eq_u32 vcc, 0, v14
    s_nop 1
    s_cbranch_vccz D_8
    s_sleep 1
    s_sub_u32 s4, s4, 1
    s_cbranch_scc0 P_7
D_8:
    s_nop 1
    v_readfirstlane_b32 s52, v14
L_6:
    s_waitcnt vmcnt(10)
    s_barrier
    s_cmp_lg_u32 s60, 7
    s_cbranch_scc1 L_9
    s_or_b32 s61, s64, 0
    v_mov_b32 v12, s52
    v_mov_b32 v13, s61
    v_mov_b32 v14, 0
    s_lshl_b32 s61, s5, 7
    s_add_u32 s61, s61, 11534336
    s_mov_b64 exec, 1
    buffer_store_dwordx2 v[12:13], v14, s[44:47], s61 offen sc1
    s_mov_b64 exec, -1
L_9:
    v_lshrrev_b32 v5, 3, v1
    v_mul_u32_u24 v5, 512, v5
    v_add_u32 v5, v5, v6
    ds_read_b128 v[64:67], v8 offset:8192
    ds_read_b64_tr_b16 v[68:69], v4 offset:0
    ds_read_b64_tr_b16 v[70:71], v4 offset:1024
    ds_read_b128 v[72:75], v8 offset:9216
    ds_read_b64_tr_b16 v[76:77], v4 offset:2048
    ds_read_b64_tr_b16 v[78:79], v4 offset:3072
    ds_read_b128 v[80:83], v8 offset:10240
    ds_read_b64_tr_b16 v[84:85], v4 offset:4096
    ds_read_b64_tr_b16 v[86:87], v4 offset:5120
    ds_read_b128 v[88:91], v8 offset:11264
    ds_read_b64_tr_b16 v[92:93], v4 offset:6144
    ds_read_b64_tr_b16 v[94:95], v4 offset:7168
    ds_read_b128 v[96:99], v8 offset:12288
    ds_read_b64_tr_b16 v[100:101], v4 offset:8192
    ds_read_b64_tr_b16 v[102:103], v4 offset:9216
    s_waitcnt lgkmcnt(12)
    v_mfma_f32_32x32x16_bf16 v[32:47], v[68:71], v[64:67], v[32:47]
    ds_read_b128 v[104:107], v8 offset:13312
    ds_read_b64_tr_b16 v[108:109], v4 offset:10240
    ds_read_b64_tr_b16 v[110:111], v4 offset:11264
    s_add_u32 m0, s72, 0
    s_add_u32 s75, s70, 0
    buffer_load_dwordx4 v5, s[76:79], s75 offen lds
    s_waitcnt lgkmcnt(12)
    v_mfma_f32_32x32x16_bf16 v[32:47], v[76:79], v[72:75], v[32:47]
    ds_read_b128 v[64:67], v8 offset:14336
    ds_read_b64_tr_b16 v[68:69], v4 offset:12288
    ds_read_b64_tr_b16 v[70:71], v4 offset:13312
    s_add_u32 m0, s72, 1024
    s_add_u32 s75, s70, 4096
    buffer_load_dwordx4 v5, s[76:79], s75 offen lds
    s_waitcnt lgkmcnt(12)
    v_mfma_f32_32x32x16_bf16 v[32:47], v[84:87], v[80:83], v[32:47]
    ds_read_b128 v[72:75], v8 offset:15360
    ds_read_b64_tr_b16 v[76:77], v4 offset:14336
    ds_read_b64_tr_b16 v[78:79], v4 offset:15360
    s_add_u32 m0, s72, 2048
    s_add_u32 s75, s70, 8192
    buffer_load_dwordx4 v5, s[76:79], s75 offen lds
    s_waitcnt lgkmcnt(12)
    v_mfma_f32_32x32x16_bf16 v[32:47], v[92:95], v[88:91], v[32:47]
    s_add_u32 m0, s72, 3072
    s_add_u32 s75, s70, 12288
    buffer_load_dwordx4 v5, s[76:79], s75 offen lds
    s_waitcnt lgkmcnt(9)
    v_mfma_f32_32x32x16_bf16 v[32:47], v[100:103], v[96:99], v[32:47]
    s_add_u32 m0, s72, 4096
    s_add_u32 s75, s70, 16384
    buffer_load_dwordx4 v5, s[76:79], s75 offen lds
    s_waitcnt lgkmcnt(6)
    v_mfma_f32_32x32x16_bf16 v[32:47], v[108:111], v[104:107], v[32:47]
    s_add_u32 m0, s72, 5120
    s_add_u32 s75, s70, 20480
    buffer_load_dwordx4 v5, s[76:79], s75 offen lds
    s_waitcnt lgkmcnt(3)
    v_mfma_f32_32x32x16_bf16 v[32:47], v[68:71], v[64:67], v[32:47]
    s_add_u32 m0, s72, 6144
    s_add_u32 s75, s70, 24576
    buffer_load_dwordx4 v5, s[76:79], s75 offen lds
    s_waitcnt lgkmcnt(0)
    v_mfma_f32_32x32x16_bf16 v[32:47], v[76:79], v[72:75], v[32:47]
    s_add_u32 m0, s72, 7168
    s_add_u32 s75, s70, 28672
    buffer_load_dwordx4 v5, s[76:79], s75 offen lds
    s_barrier
    v_lshrrev_b32 v5, 3, v1
    v_mul_u32_u24 v5, 512, v5
    v_add_u32 v5, v5, v6
    s_mov_b32 s6, 0xbfb8aa3b
    s_mov_b32 s7, 0xbfb8aa3b
    s_nop 2
    v_pk_mul_f32 v[48:49], v[32:33], s[6:7]
    s_add_u32 m0, s72, 65536
    s_add_u32 s75, s70, 65536
    buffer_load_dwordx4 v5, s[76:79], s75 offen lds
    v_pk_mul_f32 v[50:51], v[34:35], s[6:7]
    v_pk_mul_f32 v[52:53], v[36:37], s[6:7]
    v_pk_mul_f32 v[54:55], v[38:39], s[6:7]
    v_pk_mul_f32 v[56:57], v[40:41], s[6:7]
    v_pk_mul_f32 v[58:59], v[42:43], s[6:7]
    v_pk_mul_f32 v[60:61], v[44:45], s[6:7]
    v_pk_mul_f32 v[62:63], v[46:47], s[6:7]
    v_exp_f32 v48, v48
    v_exp_f32 v49, v49
    s_add_u32 m0, s72, 66560
    s_add_u32 s75, s70, 69632
    buffer_load_dwordx4 v5, s[76:79], s75 offen lds
    v_exp_f32 v50, v50
    v_exp_f32 v51, v51
    v_exp_f32 v52, v52
    v_exp_f32 v53, v53
    v_exp_f32 v54, v54
    s_add_u32 m0, s72, 67584
    s_add_u32 s75, s70, 73728
    buffer_load_dwordx4 v5, s[76:79], s75 offen lds
    v_exp_f32 v55, v55
    v_exp_f32 v56, v56
    v_exp_f32 v57, v57
    v_exp_f32 v58, v58
    v_exp_f32 v59, v59
    s_add_u32 m0, s72, 68608
    s_add_u32 s75, s70, 77824
    buffer_load_dwordx4 v5, s[76:79], s75 offen lds
    v_exp_f32 v60, v60
    v_exp_f32 v61, v61
    v_exp_f32 v62, v62
    v_exp_f32 v63, v63
    v_pk_add_f32 v[48:49], v[48:49], 1.0 op_sel_hi:[1,0]
    v_pk_add_f32 v[50:51], v[50:51], 1.0 op_sel_hi:[1,0]
    s_add_u32 m0, s72, 69632
    s_add_u32 s75, s70, 81920
    buffer_load_dwordx4 v5, s[76:79], s75 offen lds
    v_pk_add_f32 v[52:53], v[52:53], 1.0 op_sel_hi:[1,0]
    v_pk_add_f32 v[54:55], v[54:55], 1.0 op_sel_hi:[1,0]
    v_pk_add_f32 v[56:57], v[56:57], 1.0 op_sel_hi:[1,0]
    v_pk_add_f32 v[58:59], v[58:59], 1.0 op_sel_hi:[1,0]
    v_pk_add_f32 v[60:61], v[60:61], 1.0 op_sel_hi:[1,0]
    v_pk_add_f32 v[62:63], v[62:63], 1.0 op_sel_hi:[1,0]
    v_rcp_f32 v48, v48
    v_rcp_f32 v49, v49
    s_add_u32 m0, s72, 70656
    s_add_u32 s75, s70, 86016
    buffer_load_dwordx4 v5, s[76:79], s75 offen lds
    v_rcp_f32 v50, v50
    v_rcp_f32 v51, v51
    v_rcp_f32 v52, v52
    v_rcp_f32 v53, v53
    v_rcp_f32 v54, v54
    s_add_u32 m0, s72, 71680
    s_add_u32 s75, s70, 90112
    buffer_load_dwordx4 v5, s[76:79], s75 offen lds
    v_rcp_f32 v55, v55
    v_rcp_f32 v56, v56
    v_rcp_f32 v57, v57
    v_rcp_f32 v58, v58
    v_rcp_f32 v59, v59
    s_add_u32 m0, s72, 72704
    s_add_u32 s75, s70, 94208
    buffer_load_dwordx4 v5, s[76:79], s75 offen lds
    v_rcp_f32 v60, v60
    v_rcp_f32 v61, v61
    v_rcp_f32 v62, v62
    v_rcp_f32 v63, v63
    v_pk_mul_f32 v[32:33], v[32:33], v[48:49]
    v_pk_mul_f32 v[34:35], v[34:35], v[50:51]
    v_pk_mul_f32 v[36:37], v[36:37], v[52:53]
    v_pk_mul_f32 v[38:39], v[38:39], v[54:55]
    v_pk_mul_f32 v[40:41], v[40:41], v[56:57]
    v_pk_mul_f32 v[42:43], v[42:43], v[58:59]
    v_pk_mul_f32 v[44:45], v[44:45], v[60:61]
    v_pk_mul_f32 v[46:47], v[46:47], v[62:63]
    v_cvt_pk_bf16_f32 v48, v32, v33
    v_cvt_pk_bf16_f32 v49, v34, v35
    v_cvt_pk_bf16_f32 v50, v36, v37
    v_cvt_pk_bf16_f32 v51, v38, v39
    v_cvt_pk_bf16_f32 v52, v40, v41
    v_cvt_pk_bf16_f32 v53, v42, v43
    v_cvt_pk_bf16_f32 v54, v44, v45
    v_cvt_pk_bf16_f32 v55, v46, v47
    ds_write_b128 v7, v[48:51] offset:16384
    ds_write_b128 v7, v[52:55] offset:17408
    s_waitcnt vmcnt(18)
    v_lshl_or_b32 v128, v145, 16, v144
    v_lshl_or_b32 v129, v147, 16, v146
    v_lshl_or_b32 v130, v149, 16, v148
    v_lshl_or_b32 v131, v151, 16, v150
    buffer_store_dwordx4 v[128:131], v2, s[44:47], s34 offen sc1
    s_cmp_ge_u32 s84, 4
    s_cbranch_scc1 L_10
    s_cmp_lg_u32 s60, 6
    s_cbranch_scc1 L_10
    s_lshl_b32 s61, s84, 12
    s_add_u32 s61, s61, 11010048
    v_bfe_u32 v12, v1, 4, 2
    v_lshlrev_b32 v12, 7, v12
    v_bfe_u32 v13, v1, 2, 1
    v_lshl_or_b32 v12, v13, 6, v12
    v_bfe_u32 v13, v1, 3, 1
    v_lshl_or_b32 v12, v13, 5, v12
    v_bfe_u32 v13, v1, 1, 1
    v_lshl_or_b32 v12, v13, 4, v12
    v_and_b32 v13, 1, v1
    v_lshl_or_b32 v12, v13, 11, v12
    v_lshl_or_b32 v192, v193, 16, v192
    v_lshl_or_b32 v193, v195, 16, v194
    v_lshl_or_b32 v194, v197, 16, v196
    v_lshl_or_b32 v195, v199, 16, v198
    v_lshl_or_b32 v196, v201, 16, v200
    v_lshl_or_b32 v197, v203, 16, v202
    v_lshl_or_b32 v198, v205, 16, v204
    v_lshl_or_b32 v199, v207, 16, v206
    v_lshl_or_b32 v200, v209, 16, v208
    v_lshl_or_b32 v201, v211, 16, v210
    v_lshl_or_b32 v202, v213, 16, v212
    v_lshl_or_b32 v203, v215, 16, v214
    v_lshl_or_b32 v204, v217, 16, v216
    v_lshl_or_b32 v205, v219, 16, v218
    v_lshl_or_b32 v206, v221, 16, v220
    v_lshl_or_b32 v207, v223, 16, v222
    buffer_store_dwordx4 v[192:195], v12, s[44:47], s61 offen offset:0 sc1
    buffer_store_dwordx4 v[196:199], v12, s[44:47], s61 offen offset:512 sc1
    buffer_store_dwordx4 v[200:203], v12, s[44:47], s61 offen offset:1024 sc1
    buffer_store_dwordx4 v[204:207], v12, s[44:47], s61 offen offset:1536 sc1
L_10:
    s_nop 1
    s_lshl_b32 s61, s5, 12
    s_add_u32 s61, s61, 7331840
    s_cmp_lt_u32 s60, 4
    s_cselect_b32 s61, s69, s61
    s_lshl_b32 s62, s60, 11
    s_add_u32 s61, s61, s62
    s_cmp_ge_u32 s60, 6
    s_cselect_b32 s61, 0x70000000, s61
    buffer_store_dwordx4 v[184:187], v2, s[44:47], s61 offen offset:0 sc1
    buffer_store_dwordx4 v[184:187], v2, s[44:47], s61 offen offset:1024 sc1
    s_mov_b32 s36, s24
    s_mov_b32 s37, s25
    s_mov_b32 s38, 524288
    s_mov_b32 s39, 0x20000
    s_mov_b32 s76, s18
    s_mov_b32 s77, s19
    s_mov_b32 s78, 262144
    s_mov_b32 s79, 0x20000
    s_mul_i32 s63, s58, 512000
    s_add_u32 s40, s28, s63
    s_addc_u32 s41, s29, 0
    s_mov_b32 s42, 512000
    s_waitcnt vmcnt(11)
    s_waitcnt lgkmcnt(0)
    s_barrier
    ds_read_b128 v[64:67], v8 offset:16384
    ds_read_b64_tr_b16 v[68:69], v3 offset:0
    ds_read_b64_tr_b16 v[70:71], v3 offset:1024
    ds_read_b128 v[72:75], v8 offset:17408
    ds_read_b64_tr_b16 v[76:77], v3 offset:2048
    ds_read_b64_tr_b16 v[78:79], v3 offset:3072
    ds_read_b128 v[80:83], v8 offset:18432
    ds_read_b64_tr_b16 v[84:85], v3 offset:4096
    ds_read_b64_tr_b16 v[86:87], v3 offset:5120
    ds_read_b128 v[88:91], v8 offset:19456
    ds_read_b64_tr_b16 v[92:93], v3 offset:6144
    ds_read_b64_tr_b16 v[94:95], v3 offset:7168
    ds_read_b128 v[96:99], v8 offset:20480
    ds_read_b64_tr_b16 v[100:101], v3 offset:8192
    ds_read_b64_tr_b16 v[102:103], v3 offset:9216
    s_waitcnt lgkmcnt(12)
    v_mfma_f32_32x32x16_bf16 v[32:47], v[68:71], v[64:67], 0
    ds_read_b128 v[104:107], v8 offset:21504
    ds_read_b64_tr_b16 v[108:109], v3 offset:10240
    ds_read_b64_tr_b16 v[110:111], v3 offset:11264
    s_waitcnt lgkmcnt(12)
    v_mfma_f32_32x32x16_bf16 v[32:47], v[76:79], v[72:75], v[32:47]
    ds_read_b128 v[64:67], v8 offset:22528
    ds_read_b64_tr_b16 v[68:69], v3 offset:12288
    ds_read_b64_tr_b16 v[70:71], v3 offset:13312
    s_waitcnt lgkmcnt(12)
    v_mfma_f32_32x32x16_bf16 v[32:47], v[84:87], v[80:83], v[32:47]
    ds_read_b128 v[72:75], v8 offset:23552
    ds_read_b64_tr_b16 v[76:77], v3 offset:14336
    ds_read_b64_tr_b16 v[78:79], v3 offset:15360
    s_waitcnt lgkmcnt(12)
    v_mfma_f32_32x32x16_bf16 v[32:47], v[92:95], v[88:91], v[32:47]
    s_waitcnt lgkmcnt(9)
    v_mfma_f32_32x32x16_bf16 v[32:47], v[100:103], v[96:99], v[32:47]
    s_waitcnt lgkmcnt(6)
    v_mfma_f32_32x32x16_bf16 v[32:47], v[108:111], v[104:107], v[32:47]
    s_waitcnt lgkmcnt(3)
    v_mfma_f32_32x32x16_bf16 v[32:47], v[68:71], v[64:67], v[32:47]
    s_waitcnt lgkmcnt(0)
    v_mfma_f32_32x32x16_bf16 v[32:47], v[76:79], v[72:75], v[32:47]
    s_cmp_lg_u32 s60, 7
    s_cbranch_scc1 L_11
    v_and_b32 v13, 3, v1
    v_lshlrev_b32 v13, 7, v13
    s_lshl_b32 s61, s57, 9
    s_add_u32 s61, s61, 11534336
    s_movk_i32 s4, 0x4000
    s_nop 1
P_12:
    s_add_u32 s62, s61, 0
    buffer_load_dwordx2 v[128:129], v13, s[44:47], s62 offen sc1
    s_waitcnt vmcnt(0)
    v_mov_b32 v12, 0
    v_xor_b32 v14, s52, v128
    v_or_b32 v12, v12, v14
    v_not_b32 v14, v129
    v_and_b32 v14, 16, v14
    v_or_b32 v12, v12, v14
    v_cmp_ne_u32 vcc, 0, v12
    s_nop 1
    s_cbranch_vccz D_13
    s_sleep 1
    s_sub_u32 s4, s4, 1
    s_cbranch_scc0 P_12
D_13:
    s_nop 1
    v_and_b32 v14, 31, v129
    v_cmp_ne_u32 vcc, s64, v14
    s_nop 1
    s_cmp_eq_u64 vcc, 0
    s_cselect_b32 s61, 1, 0
    v_mov_b32 v14, s61
    v_mov_b32 v13, 131072
    ds_write_b32 v13, v14
    s_waitcnt lgkmcnt(0)
L_11:
    s_waitcnt vmcnt(3)
    s_barrier
    v_mov_b32 v13, 131072
    ds_read_b32 v15, v13
    v_lshrrev_b32 v5, 3, v1
    v_mul_u32_u24 v5, 1536, v5
    v_add_u32 v5, v5, v6
    s_cmp_ge_u32 s60, 6
    s_cbranch_scc1 L_14
    ds_read_b128 v[64:67], v8 offset:24576
    ds_read_b64_tr_b16 v[68:69], v4 offset:0
    ds_read_b64_tr_b16 v[70:71], v4 offset:1024
    ds_read_b128 v[72:75], v8 offset:25600
    ds_read_b64_tr_b16 v[76:77], v4 offset:2048
    ds_read_b64_tr_b16 v[78:79], v4 offset:3072
    ds_read_b128 v[80:83], v8 offset:26624
    ds_read_b64_tr_b16 v[84:85], v4 offset:4096
    ds_read_b64_tr_b16 v[86:87], v4 offset:5120
    ds_read_b128 v[88:91], v8 offset:27648
    ds_read_b64_tr_b16 v[92:93], v4 offset:6144
    ds_read_b64_tr_b16 v[94:95], v4 offset:7168
    ds_read_b128 v[96:99], v8 offset:28672
    ds_read_b64_tr_b16 v[100:101], v4 offset:8192
    ds_read_b64_tr_b16 v[102:103], v4 offset:9216
    s_waitcnt lgkmcnt(12)
    v_mfma_f32_32x32x16_bf16 v[32:47], v[68:71], v[64:67], v[32:47]
    ds_read_b128 v[104:107], v8 offset:29696
    ds_read_b64_tr_b16 v[108:109], v4 offset:10240
    ds_read_b64_tr_b16 v[110:111], v4 offset:11264
    s_add_u32 m0, s72, 0
    s_add_u32 s75, s71, 0
    buffer_load_dwordx4 v5, s[48:51], s75 offen lds
    s_waitcnt lgkmcnt(12)
    v_mfma_f32_32x32x16_bf16 v[32:47], v[76:79], v[72:75], v[32:47]
    ds_read_b128 v[64:67], v8 offset:30720
    ds_read_b64_tr_b16 v[68:69], v4 offset:12288
    ds_read_b64_tr_b16 v[70:71], v4 offset:13312
    s_add_u32 m0, s72, 1024
    s_add_u32 s75, s71, 12288
    buffer_load_dwordx4 v5, s[48:51], s75 offen lds
    s_waitcnt lgkmcnt(12)
    v_mfma_f32_32x32x16_bf16 v[32:47], v[84:87], v[80:83], v[32:47]
    ds_read_b128 v[72:75], v8 offset:31744
    ds_read_b64_tr_b16 v[76:77], v4 offset:14336
    ds_read_b64_tr_b16 v[78:79], v4 offset:15360
    s_add_u32 m0, s72, 2048
    s_add_u32 s75, s71, 24576
    buffer_load_dwordx4 v5, s[48:51], s75 offen lds
    s_waitcnt lgkmcnt(12)
    v_mfma_f32_32x32x16_bf16 v[32:47], v[92:95], v[88:91], v[32:47]
    s_add_u32 m0, s72, 3072
    s_add_u32 s75, s71, 36864
    buffer_load_dwordx4 v5, s[48:51], s75 offen lds
    s_waitcnt lgkmcnt(9)
    v_mfma_f32_32x32x16_bf16 v[32:47], v[100:103], v[96:99], v[32:47]
    s_add_u32 m0, s72, 4096
    s_add_u32 s75, s71, 49152
    buffer_load_dwordx4 v5, s[48:51], s75 offen lds
    s_waitcnt lgkmcnt(6)
    v_mfma_f32_32x32x16_bf16 v[32:47], v[108:111], v[104:107], v[32:47]
    s_add_u32 m0, s72, 5120
    s_add_u32 s75, s71, 61440
    buffer_load_dwordx4 v5, s[48:51], s75 offen lds
    s_waitcnt lgkmcnt(3)
    v_mfma_f32_32x32x16_bf16 v[32:47], v[68:71], v[64:67], v[32:47]
    s_add_u32 m0, s72, 6144
    s_add_u32 s75, s71, 73728
    buffer_load_dwordx4 v5, s[48:51], s75 offen lds
    s_waitcnt lgkmcnt(0)
    v_mfma_f32_32x32x16_bf16 v[32:47], v[76:79], v[72:75], v[32:47]
    s_add_u32 m0, s72, 7168
    s_add_u32 s75, s71, 86016
    buffer_load_dwordx4 v5, s[48:51], s75 offen lds
    s_waitcnt vmcnt(8)
    s_branch L_15
L_14:
    ds_read_b128 v[64:67], v8 offset:24576
    ds_read_b64_tr_b16 v[68:69], v4 offset:0
    ds_read_b64_tr_b16 v[70:71], v4 offset:1024
    ds_read_b128 v[72:75], v8 offset:25600
    ds_read_b64_tr_b16 v[76:77], v4 offset:2048
    ds_read_b64_tr_b16 v[78:79], v4 offset:3072
    ds_read_b128 v[80:83], v8 offset:26624
    ds_read_b64_tr_b16 v[84:85], v4 offset:4096
    ds_read_b64_tr_b16 v[86:87], v4 offset:5120
    ds_read_b128 v[88:91], v8 offset:27648
    ds_read_b64_tr_b16 v[92:93], v4 offset:6144
    ds_read_b64_tr_b16 v[94:95], v4 offset:7168
    ds_read_b128 v[96:99], v8 offset:28672
    ds_read_b64_tr_b16 v[100:101], v4 offset:8192
    ds_read_b64_tr_b16 v[102:103], v4 offset:9216
    s_waitcnt lgkmcnt(12)
    v_mfma_f32_32x32x16_bf16 v[32:47], v[68:71], v[64:67], v[32:47]
    ds_read_b128 v[104:107], v8 offset:29696
    ds_read_b64_tr_b16 v[108:109], v4 offset:10240
    ds_read_b64_tr_b16 v[110:111], v4 offset:11264
    s_waitcnt lgkmcnt(12)
    v_mfma_f32_32x32x16_bf16 v[32:47], v[76:79], v[72:75], v[32:47]
    ds_read_b128 v[64:67], v8 offset:30720
    ds_read_b64_tr_b16 v[68:69], v4 offset:12288
    ds_read_b64_tr_b16 v[70:71], v4 offset:13312
    s_waitcnt lgkmcnt(12)
    v_mfma_f32_32x32x16_bf16 v[32:47], v[84:87], v[80:83], v[32:47]
    ds_read_b128 v[72:75], v8 offset:31744
    ds_read_b64_tr_b16 v[76:77], v4 offset:14336
    ds_read_b64_tr_b16 v[78:79], v4 offset:15360
    s_waitcnt lgkmcnt(12)
    v_mfma_f32_32x32x16_bf16 v[32:47], v[92:95], v[88:91], v[32:47]
    s_waitcnt lgkmcnt(9)
    v_mfma_f32_32x32x16_bf16 v[32:47], v[100:103], v[96:99], v[32:47]
    s_waitcnt lgkmcnt(6)
    v_mfma_f32_32x32x16_bf16 v[32:47], v[108:111], v[104:107], v[32:47]
    s_waitcnt lgkmcnt(3)
    v_mfma_f32_32x32x16_bf16 v[32:47], v[68:71], v[64:67], v[32:47]
    s_waitcnt lgkmcnt(0)
    v_mfma_f32_32x32x16_bf16 v[32:47], v[76:79], v[72:75], v[32:47]
    s_waitcnt vmcnt(0)
L_15:
    v_readfirstlane_b32 s65, v15
    s_nop 1
    s_cmp_lg_u32 s65, 0
    s_cbranch_scc1 L_16
    v_mov_b32 v56, -1
    v_mov_b32 v57, -1
    v_mov_b32 v58, -1
    v_mov_b32 v59, -1
    buffer_store_dwordx4 v[56:59], v2, s[44:47], s66 offen offset:0 sc1
    buffer_store_dwordx4 v[56:59], v2, s[44:47], s66 offen offset:1024 sc1
    s_lshr_b32 s61, s60, 2
    s_mul_i32 s61, s61, 2093056
    s_add_u32 s61, s61, s67
    s_add_u32 s61, s61, 6291456
    buffer_store_dwordx4 v[56:59], v2, s[44:47], s61 offen sc1
    s_waitcnt vmcnt(0)
    s_barrier
    s_cmp_lg_u32 s60, 7
    s_cbranch_scc1 L_17
    s_or_b32 s64, s64, 32
    s_or_b32 s61, s64, 0
    v_mov_b32 v12, s52
    v_mov_b32 v13, s61
    v_mov_b32 v14, 0
    s_lshl_b32 s61, s5, 7
    s_add_u32 s61, s61, 11534336
    s_mov_b64 exec, 1
    buffer_store_dwordx2 v[12:13], v14, s[44:47], s61 offen sc1
    s_mov_b64 exec, -1
    v_and_b32 v13, 3, v1
    v_lshlrev_b32 v13, 7, v13
    s_lshl_b32 s61, s57, 9
    s_add_u32 s61, s61, 11534336
    s_movk_i32 s4, 0x4000
    s_nop 1
P_18:
    s_add_u32 s62, s61, 0
    buffer_load_dwordx2 v[128:129], v13, s[44:47], s62 offen sc1
    s_waitcnt vmcnt(0)
    v_mov_b32 v12, 0
    v_xor_b32 v14, s52, v128
    v_or_b32 v12, v12, v14
    v_not_b32 v14, v129
    v_and_b32 v14, 32, v14
    v_or_b32 v12, v12, v14
    v_cmp_ne_u32 vcc, 0, v12
    s_nop 1
    s_cbranch_vccz D_19
    s_sleep 1
    s_sub_u32 s4, s4, 1
    s_cbranch_scc0 P_18
D_19:
    s_nop 1
L_17:
    s_barrier
L_16:
    v_cvt_pk_bf16_f32 v48, v32, v33
    v_cvt_pk_bf16_f32 v49, v34, v35
    v_cvt_pk_bf16_f32 v50, v36, v37
    v_cvt_pk_bf16_f32 v51, v38, v39
    v_cvt_pk_bf16_f32 v52, v40, v41
    v_cvt_pk_bf16_f32 v53, v42, v43
    v_cvt_pk_bf16_f32 v54, v44, v45
    v_cvt_pk_bf16_f32 v55, v46, v47
    s_cmp_eq_u32 s65, 0
    s_cbranch_scc1 L_20
    buffer_store_dwordx4 v[48:51], v2, s[44:47], s66 offen
    buffer_store_dwordx4 v[52:55], v2, s[44:47], s66 offen offset:1024
    s_branch L_21
L_20:
    buffer_store_dwordx4 v[48:51], v2, s[44:47], s66 offen sc1
    buffer_store_dwordx4 v[52:55], v2, s[44:47], s66 offen offset:1024 sc1
L_21:
    s_barrier
    s_cmp_lg_u32 s60, 7
    s_cbranch_scc1 L_23
    s_or_b32 s61, s64, 64
    v_mov_b32 v12, s52
    v_mov_b32 v13, s61
    v_mov_b32 v14, 0
    s_lshl_b32 s61, s5, 7
    s_add_u32 s61, s61, 11534336
    s_mov_b64 exec, 1
    buffer_store_dwordx2 v[12:13], v14, s[44:47], s61 offen sc1
    s_mov_b64 exec, -1
L_23:
    v_lshrrev_b32 v5, 3, v1
    v_mul_u32_u24 v5, 1536, v5
    v_add_u32 v5, v5, v6
    s_xor_b32 s62, s66, 0x4000
    s_xor_b32 s63, s66, 0x8000
    s_xor_b32 s3, s66, 0xc000
    v_pk_fma_f32 v[16:17], v[32:33], 0.5, v[16:17] op_sel_hi:[1,0,1]
    v_pk_fma_f32 v[18:19], v[34:35], 0.5, v[18:19] op_sel_hi:[1,0,1]
    v_pk_fma_f32 v[20:21], v[36:37], 0.5, v[20:21] op_sel_hi:[1,0,1]
    v_pk_fma_f32 v[22:23], v[38:39], 0.5, v[22:23] op_sel_hi:[1,0,1]
    v_pk_fma_f32 v[24:25], v[40:41], 0.5, v[24:25] op_sel_hi:[1,0,1]
    v_pk_fma_f32 v[26:27], v[42:43], 0.5, v[26:27] op_sel_hi:[1,0,1]
    v_pk_fma_f32 v[28:29], v[44:45], 0.5, v[28:29] op_sel_hi:[1,0,1]
    v_pk_fma_f32 v[30:31], v[46:47], 0.5, v[30:31] op_sel_hi:[1,0,1]
    v_mov_b32 v14, 0x3f00
    v_mov_b32 v15, 0.5
    s_movk_i32 s4, 0x4000
    s_nop 1
P_24:
    buffer_load_dwordx4 v[128:131], v2, s[44:47], s62 offen offset:0 sc1
    buffer_load_dwordx4 v[132:135], v2, s[44:47], s62 offen offset:1024 sc1
    buffer_load_dwordx4 v[136:139], v2, s[44:47], s63 offen offset:0 sc1
    buffer_load_dwordx4 v[140:143], v2, s[44:47], s63 offen offset:1024 sc1
    buffer_load_dwordx4 v[144:147], v2, s[44:47], s3 offen offset:0 sc1
    buffer_load_dwordx4 v[148:151], v2, s[44:47], s3 offen offset:1024 sc1
    s_waitcnt vmcnt(0)
    v_max_u32 v12, v128, v129
    v_max3_u32 v12, v12, v130, v131
    v_max3_u32 v12, v12, v132, v133
    v_max3_u32 v12, v12, v134, v135
    v_max3_u32 v12, v12, v136, v137
    v_max3_u32 v12, v12, v138, v139
    v_max3_u32 v12, v12, v140, v141
    v_max3_u32 v12, v12, v142, v143
    v_max3_u32 v12, v12, v144, v145
    v_max3_u32 v12, v12, v146, v147
    v_max3_u32 v12, v12, v148, v149
    v_max3_u32 v12, v12, v150, v151
    v_cmp_eq_u32 vcc, -1, v12
    s_nop 1
    s_cbranch_vccz D_25
    s_sleep 1
    s_sub_u32 s4, s4, 1
    s_cbranch_scc0 P_24
D_25:
    s_nop 1
    v_dot2c_f32_bf16 v16, v128, v14
    s_add_u32 m0, s72, 65536
    s_add_u32 s75, s71, 196608
    buffer_load_dwordx4 v5, s[48:51], s75 offen lds
    v_dot2c_f32_bf16 v17, v128, v15
    v_dot2c_f32_bf16 v18, v129, v14
    v_dot2c_f32_bf16 v19, v129, v15
    v_dot2c_f32_bf16 v20, v130, v14
    v_dot2c_f32_bf16 v21, v130, v15
    v_dot2c_f32_bf16 v22, v131, v14
    v_dot2c_f32_bf16 v23, v131, v15
    v_dot2c_f32_bf16 v24, v132, v14
    s_add_u32 m0, s72, 66560
    s_add_u32 s75, s71, 208896
    buffer_load_dwordx4 v5, s[48:51], s75 offen lds
    v_dot2c_f32_bf16 v25, v132, v15
    v_dot2c_f32_bf16 v26, v133, v14
    v_dot2c_f32_bf16 v27, v133, v15
    v_dot2c_f32_bf16 v28, v134, v14
    v_dot2c_f32_bf16 v29, v134, v15
    v_dot2c_f32_bf16 v30, v135, v14
    v_dot2c_f32_bf16 v31, v135, v15
    v_dot2c_f32_bf16 v16, v136, v14
    s_add_u32 m0, s72, 67584
    s_add_u32 s75, s71, 221184
    buffer_load_dwordx4 v5, s[48:51], s75 offen lds
    v_dot2c_f32_bf16 v17, v136, v15
    v_dot2c_f32_bf16 v18, v137, v14
    v_dot2c_f32_bf16 v19, v137, v15
    v_dot2c_f32_bf16 v20, v138, v14
    v_dot2c_f32_bf16 v21, v138, v15
    v_dot2c_f32_bf16 v22, v139, v14
    v_dot2c_f32_bf16 v23, v139, v15
    v_dot2c_f32_bf16 v24, v140, v14
    s_add_u32 m0, s72, 68608
    s_add_u32 s75, s71, 233472
    buffer_load_dwordx4 v5, s[48:51], s75 offen lds
    v_dot2c_f32_bf16 v25, v140, v15
    v_dot2c_f32_bf16 v26, v141, v14
    v_dot2c_f32_bf16 v27, v141, v15
    v_dot2c_f32_bf16 v28, v142, v14
    v_dot2c_f32_bf16 v29, v142, v15
    v_dot2c_f32_bf16 v30, v143, v14
    v_dot2c_f32_bf16 v31, v143, v15
    v_dot2c_f32_bf16 v16, v144, v14
    s_add_u32 m0, s72, 69632
    s_add_u32 s75, s71, 245760
    buffer_load_dwordx4 v5, s[48:51], s75 offen lds
    v_dot2c_f32_bf16 v17, v144, v15
    v_dot2c_f32_bf16 v18, v145, v14
    v_dot2c_f32_bf16 v19, v145, v15
    v_dot2c_f32_bf16 v20, v146, v14
    v_dot2c_f32_bf16 v21, v146, v15
    v_dot2c_f32_bf16 v22, v147, v14
    v_dot2c_f32_bf16 v23, v147, v15
    v_dot2c_f32_bf16 v24, v148, v14
    s_add_u32 m0, s72, 70656
    s_add_u32 s75, s71, 258048
    buffer_load_dwordx4 v5, s[48:51], s75 offen lds
    v_dot2c_f32_bf16 v25, v148, v15
    v_dot2c_f32_bf16 v26, v149, v14
    v_dot2c_f32_bf16 v27, v149, v15
    v_dot2c_f32_bf16 v28, v150, v14
    v_dot2c_f32_bf16 v29, v150, v15
    v_dot2c_f32_bf16 v30, v151, v14
    v_dot2c_f32_bf16 v31, v151, v15
    v_pk_mul_f32 v[48:49], v[16:17], v[16:17]
    s_add_u32 m0, s72, 71680
    s_add_u32 s75, s71, 270336
    buffer_load_dwordx4 v5, s[48:51], s75 offen lds
    v_pk_add_f32 v[50:51], v[16:17], v[18:19]
    v_pk_fma_f32 v[48:49], v[18:19], v[18:19], v[48:49]
    v_pk_fma_f32 v[48:49], v[20:21], v[20:21], v[48:49]
    v_pk_fma_f32 v[48:49], v[22:23], v[22:23], v[48:49]
    v_pk_fma_f32 v[48:49], v[24:25], v[24:25], v[48:49]
    v_pk_fma_f32 v[48:49], v[26:27], v[26:27], v[48:49]
    v_pk_fma_f32 v[48:49], v[28:29], v[28:29], v[48:49]
    v_pk_fma_f32 v[48:49], v[30:31], v[30:31], v[48:49]
    s_add_u32 m0, s72, 72704
    s_add_u32 s75, s71, 282624
    buffer_load_dwordx4 v5, s[48:51], s75 offen lds
    v_pk_add_f32 v[50:51], v[50:51], v[20:21]
    v_pk_add_f32 v[50:51], v[50:51], v[22:23]
    v_pk_add_f32 v[50:51], v[50:51], v[24:25]
    v_pk_add_f32 v[50:51], v[50:51], v[26:27]
    v_pk_add_f32 v[50:51], v[50:51], v[28:29]
    v_pk_add_f32 v[50:51], v[50:51], v[30:31]
    v_add_f32 v13, v48, v49
    v_add_f32 v12, v50, v51
    s_nop 1
    v_permlane32_swap_b32 v12, v13
    v_add_f32 v12, v12, v13
    ds_write_b32 v9, v12
    s_waitcnt lgkmcnt(0)
    s_barrier
    ds_read2st64_b32 v[48:49], v10 offset0:0 offset1:1
    ds_read2st64_b32 v[50:51], v10 offset0:2 offset1:3
    ds_read2st64_b32 v[52:53], v10 offset0:4 offset1:5
    ds_read2st64_b32 v[54:55], v10 offset0:6 offset1:7
    s_and_b32 s61, s5, 31
    s_lshl_b32 s61, s61, 3
    s_add_u32 s61, s61, s60
    s_lshl_b32 s62, s61, 10
    s_lshl_b32 s61, s61, 11
    v_and_b32 v15, 15, v1
    v_lshlrev_b32 v15, 7, v15
    buffer_load_dword v250, v15, s[36:39], s61 offen
    v_and_b32 v15, 0x3ff, v15
    buffer_load_dword v251, v15, s[76:79], s62 offen
    s_waitcnt lgkmcnt(0)
    v_pk_add_f32 v[48:49], v[48:49], v[50:51]
    v_pk_add_f32 v[52:53], v[52:53], v[54:55]
    v_pk_add_f32 v[48:49], v[48:49], v[52:53]
    v_add_f32 v12, v48, v49
    v_mul_f32 v12, 0x3b800000, v12
    v_mov_b32 v13, v12
    s_nop 1
    v_permlane32_swap_b32 v12, v13
    v_fma_f32 v13, -v12, v12, v13
    v_max_f32 v13, 0, v13
    v_add_f32 v13, 0x3727c5ac, v13
    v_rsq_f32 v14, v13
    s_nop 0
    v_mul_f32_e64 v15, -v12, v14
    v_pk_fma_f32 v[48:49], v[16:17], v[14:15], v[14:15] op_sel:[0,0,1] op_sel_hi:[1,0,1]
    v_pk_fma_f32 v[50:51], v[18:19], v[14:15], v[14:15] op_sel:[0,0,1] op_sel_hi:[1,0,1]
    v_pk_fma_f32 v[52:53], v[20:21], v[14:15], v[14:15] op_sel:[0,0,1] op_sel_hi:[1,0,1]
    v_pk_fma_f32 v[54:55], v[22:23], v[14:15], v[14:15] op_sel:[0,0,1] op_sel_hi:[1,0,1]
    v_pk_fma_f32 v[56:57], v[24:25], v[14:15], v[14:15] op_sel:[0,0,1] op_sel_hi:[1,0,1]
    v_pk_fma_f32 v[58:59], v[26:27], v[14:15], v[14:15] op_sel:[0,0,1] op_sel_hi:[1,0,1]
    v_pk_fma_f32 v[60:61], v[28:29], v[14:15], v[14:15] op_sel:[0,0,1] op_sel_hi:[1,0,1]
    v_pk_fma_f32 v[62:63], v[30:31], v[14:15], v[14:15] op_sel:[0,0,1] op_sel_hi:[1,0,1]
    v_cvt_pk_bf16_f32 v48, v48, v49
    v_cvt_pk_bf16_f32 v49, v50, v51
    v_cvt_pk_bf16_f32 v50, v52, v53
    v_cvt_pk_bf16_f32 v51, v54, v55
    v_cvt_pk_bf16_f32 v52, v56, v57
    v_cvt_pk_bf16_f32 v53, v58, v59
    v_cvt_pk_bf16_f32 v54, v60, v61
    v_cvt_pk_bf16_f32 v55, v62, v63
    ds_write_b128 v7, v[48:51]
    ds_write_b128 v7, v[52:55] offset:1024
    s_waitcnt vmcnt(2)
    s_waitcnt lgkmcnt(0)
    s_barrier
    s_cmp_lg_u32 s60, 7
    s_cbranch_scc1 L_28
    v_lshlrev_b32 v13, 7, v1
    s_mov_b32 s61, 11534336
    s_movk_i32 s4, 0x4000
    s_nop 1
P_29:
    s_add_u32 s62, s61, 0
    buffer_load_dwordx2 v[128:129], v13, s[44:47], s62 offen sc1
    s_add_u32 s62, s61, 8192
    buffer_load_dwordx2 v[130:131], v13, s[44:47], s62 offen sc1
    s_add_u32 s62, s61, 16384
    buffer_load_dwordx2 v[132:133], v13, s[44:47], s62 offen sc1
    s_add_u32 s62, s61, 24576
    buffer_load_dwordx2 v[134:135], v13, s[44:47], s62 offen sc1
    s_waitcnt vmcnt(0)
    v_mov_b32 v12, 0
    v_xor_b32 v14, s52, v128
    v_or_b32 v12, v12, v14
    v_not_b32 v14, v129
    v_and_b32 v14, 64, v14
    v_or_b32 v12, v12, v14
    v_xor_b32 v14, s52, v130
    v_or_b32 v12, v12, v14
    v_not_b32 v14, v131
    v_and_b32 v14, 64, v14
    v_or_b32 v12, v12, v14
    v_xor_b32 v14, s52, v132
    v_or_b32 v12, v12, v14
    v_not_b32 v14, v133
    v_and_b32 v14, 64, v14
    v_or_b32 v12, v12, v14
    v_xor_b32 v14, s52, v134
    v_or_b32 v12, v12, v14
    v_not_b32 v14, v135
    v_and_b32 v14, 64, v14
    v_or_b32 v12, v12, v14
    v_cmp_ne_u32 vcc, 0, v12
    s_nop 1
    s_cbranch_vccz D_30
    s_sleep 1
    s_sub_u32 s4, s4, 1
    s_cbranch_scc0 P_29
D_30:
    s_nop 1
L_28:
    s_cmp_ge_u32 s60, 6
    s_cbranch_scc1 L_27
    s_cmp_ge_u32 s60, 4
    s_cbranch_scc1 L_26
    ds_read_b128 v[64:67], v8 offset:0
    ds_read_b64_tr_b16 v[68:69], v3 offset:0
    ds_read_b64_tr_b16 v[70:71], v3 offset:1024
    ds_read_b128 v[72:75], v8 offset:1024
    ds_read_b64_tr_b16 v[76:77], v3 offset:2048
    ds_read_b64_tr_b16 v[78:79], v3 offset:3072
    ds_read_b128 v[80:83], v8 offset:2048
    ds_read_b64_tr_b16 v[84:85], v3 offset:4096
    ds_read_b64_tr_b16 v[86:87], v3 offset:5120
    ds_read_b128 v[88:91], v8 offset:3072
    ds_read_b64_tr_b16 v[92:93], v3 offset:6144
    ds_read_b64_tr_b16 v[94:95], v3 offset:7168
    ds_read_b128 v[96:99], v8 offset:4096
    ds_read_b64_tr_b16 v[100:101], v3 offset:8192
    ds_read_b64_tr_b16 v[102:103], v3 offset:9216
    s_waitcnt lgkmcnt(12)
    v_mfma_f32_32x32x16_bf16 v[32:47], v[68:71], v[64:67], 0
    ds_read_b128 v[104:107], v8 offset:5120
    ds_read_b64_tr_b16 v[108:109], v3 offset:10240
    ds_read_b64_tr_b16 v[110:111], v3 offset:11264
    s_waitcnt lgkmcnt(12)
    v_mfma_f32_32x32x16_bf16 v[32:47], v[76:79], v[72:75], v[32:47]
    ds_read_b128 v[64:67], v8 offset:6144
    ds_read_b64_tr_b16 v[68:69], v3 offset:12288
    ds_read_b64_tr_b16 v[70:71], v3 offset:13312
    s_waitcnt lgkmcnt(12)
    v_mfma_f32_32x32x16_bf16 v[32:47], v[84:87], v[80:83], v[32:47]
    ds_read_b128 v[72:75], v8 offset:7168
    ds_read_b64_tr_b16 v[76:77], v3 offset:14336
    ds_read_b64_tr_b16 v[78:79], v3 offset:15360
    s_waitcnt lgkmcnt(12)
    v_mfma_f32_32x32x16_bf16 v[32:47], v[92:95], v[88:91], v[32:47]
    s_waitcnt lgkmcnt(9)
    v_mfma_f32_32x32x16_bf16 v[32:47], v[100:103], v[96:99], v[32:47]
    s_waitcnt lgkmcnt(6)
    v_mfma_f32_32x32x16_bf16 v[32:47], v[108:111], v[104:107], v[32:47]
    s_waitcnt lgkmcnt(3)
    v_mfma_f32_32x32x16_bf16 v[32:47], v[68:71], v[64:67], v[32:47]
    s_waitcnt lgkmcnt(0)
    v_mfma_f32_32x32x16_bf16 v[32:47], v[76:79], v[72:75], v[32:47]
    ds_read_b128 v[128:131], v8 offset:8192
    ds_read_b64_tr_b16 v[132:133], v4 offset:0
    ds_read_b64_tr_b16 v[134:135], v4 offset:1024
    ds_read_b128 v[136:139], v8 offset:9216
    ds_read_b64_tr_b16 v[140:141], v4 offset:2048
    ds_read_b64_tr_b16 v[142:143], v4 offset:3072
    ds_read_b128 v[144:147], v8 offset:10240
    ds_read_b64_tr_b16 v[148:149], v4 offset:4096
    ds_read_b64_tr_b16 v[150:151], v4 offset:5120
    ds_read_b128 v[152:155], v8 offset:11264
    ds_read_b64_tr_b16 v[156:157], v4 offset:6144
    ds_read_b64_tr_b16 v[158:159], v4 offset:7168
    ds_read_b128 v[160:163], v8 offset:12288
    ds_read_b64_tr_b16 v[164:165], v4 offset:8192
    ds_read_b64_tr_b16 v[166:167], v4 offset:9216
    s_waitcnt lgkmcnt(12)
    v_mfma_f32_32x32x16_bf16 v[32:47], v[132:135], v[128:131], v[32:47]
    ds_read_b128 v[168:171], v8 offset:13312
    ds_read_b64_tr_b16 v[172:173], v4 offset:10240
    ds_read_b64_tr_b16 v[174:175], v4 offset:11264
    s_waitcnt lgkmcnt(12)
    v_mfma_f32_32x32x16_bf16 v[32:47], v[140:143], v[136:139], v[32:47]
    ds_read_b128 v[128:131], v8 offset:14336
    ds_read_b64_tr_b16 v[132:133], v4 offset:12288
    ds_read_b64_tr_b16 v[134:135], v4 offset:13312
    s_waitcnt lgkmcnt(12)
    v_mfma_f32_32x32x16_bf16 v[32:47], v[148:151], v[144:147], v[32:47]
    ds_read_b128 v[136:139], v8 offset:15360
    ds_read_b64_tr_b16 v[140:141], v4 offset:14336
    ds_read_b64_tr_b16 v[142:143], v4 offset:15360
    s_waitcnt lgkmcnt(12)
    v_mfma_f32_32x32x16_bf16 v[32:47], v[156:159], v[152:155], v[32:47]
    s_waitcnt lgkmcnt(9)
    v_mfma_f32_32x32x16_bf16 v[32:47], v[164:167], v[160:163], v[32:47]
    s_waitcnt lgkmcnt(6)
    v_mfma_f32_32x32x16_bf16 v[32:47], v[172:175], v[168:171], v[32:47]
    s_waitcnt lgkmcnt(3)
    v_mfma_f32_32x32x16_bf16 v[32:47], v[132:135], v[128:131], v[32:47]
    s_waitcnt lgkmcnt(0)
    v_mfma_f32_32x32x16_bf16 v[32:47], v[140:143], v[136:139], v[32:47]
    s_branch L_27
L_26:
    ds_read_b128 v[64:67], v8 offset:0
    ds_read_b64_tr_b16 v[68:69], v3 offset:0
    ds_read_b64_tr_b16 v[70:71], v3 offset:1024
    ds_read_b128 v[72:75], v8 offset:1024
    ds_read_b64_tr_b16 v[76:77], v3 offset:2048
    ds_read_b64_tr_b16 v[78:79], v3 offset:3072
    ds_read_b128 v[80:83], v8 offset:2048
    ds_read_b64_tr_b16 v[84:85], v3 offset:4096
    ds_read_b64_tr_b16 v[86:87], v3 offset:5120
    ds_read_b128 v[88:91], v8 offset:3072
    ds_read_b64_tr_b16 v[92:93], v3 offset:6144
    ds_read_b64_tr_b16 v[94:95], v3 offset:7168
    ds_read_b128 v[96:99], v8 offset:4096
    ds_read_b64_tr_b16 v[100:101], v3 offset:8192
    ds_read_b64_tr_b16 v[102:103], v3 offset:9216
    s_waitcnt lgkmcnt(12)
    v_mfma_f32_32x32x16_bf16 v[32:47], v[64:67], v[68:71], 0
    ds_read_b128 v[104:107], v8 offset:5120
    ds_read_b64_tr_b16 v[108:109], v3 offset:10240
    ds_read_b64_tr_b16 v[110:111], v3 offset:11264
    s_waitcnt lgkmcnt(12)
    v_mfma_f32_32x32x16_bf16 v[32:47], v[72:75], v[76:79], v[32:47]
    ds_read_b128 v[64:67], v8 offset:6144
    ds_read_b64_tr_b16 v[68:69], v3 offset:12288
    ds_read_b64_tr_b16 v[70:71], v3 offset:13312
    s_waitcnt lgkmcnt(12)
    v_mfma_f32_32x32x16_bf16 v[32:47], v[80:83], v[84:87], v[32:47]
    ds_read_b128 v[72:75], v8 offset:7168
    ds_read_b64_tr_b16 v[76:77], v3 offset:14336
    ds_read_b64_tr_b16 v[78:79], v3 offset:15360
    s_waitcnt lgkmcnt(12)
    v_mfma_f32_32x32x16_bf16 v[32:47], v[88:91], v[92:95], v[32:47]
    s_waitcnt lgkmcnt(9)
    v_mfma_f32_32x32x16_bf16 v[32:47], v[96:99], v[100:103], v[32:47]
    s_waitcnt lgkmcnt(6)
    v_mfma_f32_32x32x16_bf16 v[32:47], v[104:107], v[108:111], v[32:47]
    s_waitcnt lgkmcnt(3)
    v_mfma_f32_32x32x16_bf16 v[32:47], v[64:67], v[68:71], v[32:47]
    s_waitcnt lgkmcnt(0)
    v_mfma_f32_32x32x16_bf16 v[32:47], v[72:75], v[76:79], v[32:47]
    ds_read_b128 v[128:131], v8 offset:8192
    ds_read_b64_tr_b16 v[132:133], v4 offset:0
    ds_read_b64_tr_b16 v[134:135], v4 offset:1024
    ds_read_b128 v[136:139], v8 offset:9216
    ds_read_b64_tr_b16 v[140:141], v4 offset:2048
    ds_read_b64_tr_b16 v[142:143], v4 offset:3072
    ds_read_b128 v[144:147], v8 offset:10240
    ds_read_b64_tr_b16 v[148:149], v4 offset:4096
    ds_read_b64_tr_b16 v[150:151], v4 offset:5120
    ds_read_b128 v[152:155], v8 offset:11264
    ds_read_b64_tr_b16 v[156:157], v4 offset:6144
    ds_read_b64_tr_b16 v[158:159], v4 offset:7168
    ds_read_b128 v[160:163], v8 offset:12288
    ds_read_b64_tr_b16 v[164:165], v4 offset:8192
    ds_read_b64_tr_b16 v[166:167], v4 offset:9216
    s_waitcnt lgkmcnt(12)
    v_mfma_f32_32x32x16_bf16 v[32:47], v[128:131], v[132:135], v[32:47]
    ds_read_b128 v[168:171], v8 offset:13312
    ds_read_b64_tr_b16 v[172:173], v4 offset:10240
    ds_read_b64_tr_b16 v[174:175], v4 offset:11264
    s_waitcnt lgkmcnt(12)
    v_mfma_f32_32x32x16_bf16 v[32:47], v[136:139], v[140:143], v[32:47]
    ds_read_b128 v[128:131], v8 offset:14336
    ds_read_b64_tr_b16 v[132:133], v4 offset:12288
    ds_read_b64_tr_b16 v[134:135], v4 offset:13312
    s_waitcnt lgkmcnt(12)
    v_mfma_f32_32x32x16_bf16 v[32:47], v[144:147], v[148:151], v[32:47]
    ds_read_b128 v[136:139], v8 offset:15360
    ds_read_b64_tr_b16 v[140:141], v4 offset:14336
    ds_read_b64_tr_b16 v[142:143], v4 offset:15360
    s_waitcnt lgkmcnt(12)
    v_mfma_f32_32x32x16_bf16 v[32:47], v[152:155], v[156:159], v[32:47]
    s_waitcnt lgkmcnt(9)
    v_mfma_f32_32x32x16_bf16 v[32:47], v[160:163], v[164:167], v[32:47]
    s_waitcnt lgkmcnt(6)
    v_mfma_f32_32x32x16_bf16 v[32:47], v[168:171], v[172:175], v[32:47]
    s_waitcnt lgkmcnt(3)
    v_mfma_f32_32x32x16_bf16 v[32:47], v[128:131], v[132:135], v[32:47]
    s_waitcnt lgkmcnt(0)
    v_mfma_f32_32x32x16_bf16 v[32:47], v[136:139], v[140:143], v[32:47]
L_27:
    s_nop 11
    v_cvt_pk_bf16_f32 v48, v32, v33
    v_cvt_pk_bf16_f32 v49, v34, v35
    v_cvt_pk_bf16_f32 v50, v36, v37
    v_cvt_pk_bf16_f32 v51, v38, v39
    v_cvt_pk_bf16_f32 v52, v40, v41
    v_cvt_pk_bf16_f32 v53, v42, v43
    v_cvt_pk_bf16_f32 v54, v44, v45
    v_cvt_pk_bf16_f32 v55, v46, v47
    s_cmp_ge_u32 s60, 2
    s_cbranch_scc1 L_31
    ds_write_b128 v7, v[48:51] offset:20480
    ds_write_b128 v7, v[52:55] offset:21504
    s_branch L_32
L_31:
    s_cmp_ge_u32 s60, 6
    s_cbranch_scc1 L_32
    s_lshl_b32 s62, s60, 11
    s_add_u32 s61, s69, s62
    s_sub_u32 s61, s61, 4096
    buffer_store_dwordx4 v[48:51], v2, s[44:47], s61 offen sc1
    buffer_store_dwordx4 v[52:55], v2, s[44:47], s61 offen offset:1024 sc1
L_32:
    v_mov_b32 v12, 160768
    v_mov_b32 v13, 0
    ds_write_b32 v12, v13
    s_movk_i32 s35, 64
    s_lshl_b32 s70, s60, 14
    s_lshl_b32 s61, s56, 17
    s_add_u32 s71, s70, s61
    s_waitcnt lgkmcnt(0)
    s_barrier
    s_and_b32 s61, s5, 31
    s_mul_i32 s61, s61, 24576
    s_mul_i32 s62, s60, 3072
    s_add_u32 s61, s61, s62
    s_add_u32 s61, s61, 9437184
    v_min_u32 v15, 23, v1
    v_lshlrev_b32 v15, 7, v15
    buffer_load_dword v64, v15, s[44:47], s61 offen sc1
    s_lshr_b32 s62, s60, 2
    s_and_b32 s63, s60, 3
    s_lshl_b32 s34, s62, 9
    s_lshl_b32 s63, s63, 16
    s_add_u32 s34, s34, s63
    s_lshl_b32 s63, s56, 7
    s_add_u32 s34, s34, s63
    s_lshl_b32 s62, s62, 5
    s_mov_b32 s53, s34
    s_mov_b32 s54, s62
    s_lshr_b32 s63, s60, 1
    s_and_b32 s3, s60, 1
    s_lshl_b32 s34, s63, 7
    s_lshl_b32 s61, s3, 17
    s_add_u32 s34, s34, s61
    s_lshl_b32 s61, s56, 9
    s_add_u32 s34, s34, s61
    s_cmp_ge_u32 s60, 4
    s_cbranch_scc1 L_33
    s_lshl_b32 s61, s56, 12
    s_add_u32 s61, s61, s73
    s_add_u32 s61, s61, 11010048
    s_cmp_ge_u32 s60, 2
    s_cselect_b32 s62, 10240, 0
    s_add_u32 s62, s62, s73
    s_add_u32 m0, s62, 149504
    s_nop 0
    buffer_load_dwordx4 v2, s[44:47], s61 offen sc1 lds
L_33:
    s_add_u32 m0, s72, 0
    s_add_u32 s75, s70, 9437184
    buffer_load_dwordx4 v2, s[44:47], s75 offen offset:0 sc1 lds
    buffer_load_dwordx4 v2, s[44:47], s75 offen offset:1024 sc1 lds
    buffer_load_dwordx4 v2, s[44:47], s75 offen offset:2048 sc1 lds
    buffer_load_dwordx4 v2, s[44:47], s75 offen offset:3072 sc1 lds
    s_add_u32 m0, s72, 4096
    s_add_u32 s75, s70, 9441280
    buffer_load_dwordx4 v2, s[44:47], s75 offen offset:0 sc1 lds
    buffer_load_dwordx4 v2, s[44:47], s75 offen offset:1024 sc1 lds
    buffer_load_dwordx4 v2, s[44:47], s75 offen offset:2048 sc1 lds
    buffer_load_dwordx4 v2, s[44:47], s75 offen offset:3072 sc1 lds
L_att:
    s_nop 1
    ds_read_b128 v[32:35], v8 offset:20480
    ds_read_b128 v[36:39], v8 offset:21504
    ds_read_b128 v[40:43], v8 offset:22528
    ds_read_b128 v[44:47], v8 offset:23552
    v_and_b32 v13, 31, v1
    v_lshlrev_b32 v13, 10, v13
    v_lshrrev_b32 v14, 5, v1
    v_lshl_or_b32 v13, v14, 9, v13
    s_movk_i32 s4, 0x4000
    s_nop 1
P_34:
    buffer_load_dword v14, v13, s[44:47], s68 offen offset:124 sc1
    s_waitcnt vmcnt(0)
    v_cmp_eq_u32 vcc, -1, v14
    s_nop 1
    s_cbranch_vccz D_35
    s_sleep 1
    s_sub_u32 s4, s4, 1
    s_cbranch_scc0 P_34
D_35:
    s_nop 1
    s_barrier
    s_setprio 3
    s_add_u32 s61, s68, 0
    buffer_load_dwordx4 v[64:67], v2, s[44:47], s61 offen offset:0 sc1
    buffer_load_dwordx4 v[68:71], v2, s[44:47], s61 offen offset:1024 sc1
    buffer_load_dwordx4 v[72:75], v2, s[44:47], s61 offen offset:2048 sc1
    buffer_load_dwordx4 v[76:79], v2, s[44:47], s61 offen offset:3072 sc1
    s_add_u32 s61, s68, 8192
    buffer_load_dwordx4 v[80:83], v2, s[44:47], s61 offen offset:0 sc1
    buffer_load_dwordx4 v[84:87], v2, s[44:47], s61 offen offset:1024 sc1
    buffer_load_dwordx4 v[88:91], v2, s[44:47], s61 offen offset:2048 sc1
    buffer_load_dwordx4 v[92:95], v2, s[44:47], s61 offen offset:3072 sc1
    s_add_u32 s61, s68, 16384
    buffer_load_dwordx4 v[96:99], v2, s[44:47], s61 offen offset:0 sc1
    buffer_load_dwordx4 v[100:103], v2, s[44:47], s61 offen offset:1024 sc1
    buffer_load_dwordx4 v[104:107], v2, s[44:47], s61 offen offset:2048 sc1
    buffer_load_dwordx4 v[108:111], v2, s[44:47], s61 offen offset:3072 sc1
    s_add_u32 s61, s68, 24576
    buffer_load_dwordx4 v[112:115], v2, s[44:47], s61 offen offset:0 sc1
    buffer_load_dwordx4 v[116:119], v2, s[44:47], s61 offen offset:1024 sc1
    buffer_load_dwordx4 v[120:123], v2, s[44:47], s61 offen offset:2048 sc1
    buffer_load_dwordx4 v[124:127], v2, s[44:47], s61 offen offset:3072 sc1
    s_setprio 2
    s_waitcnt lgkmcnt(0)
    s_waitcnt vmcnt(12)
    v_mfma_f32_32x32x16_bf16 v[192:207], v[64:67], v[32:35], 0
    v_mfma_f32_32x32x16_bf16 v[192:207], v[68:71], v[36:39], v[192:207]
    v_mfma_f32_32x32x16_bf16 v[192:207], v[72:75], v[40:43], v[192:207]
    v_mfma_f32_32x32x16_bf16 v[192:207], v[76:79], v[44:47], v[192:207]
    s_waitcnt vmcnt(8)
    v_mfma_f32_32x32x16_bf16 v[208:223], v[80:83], v[32:35], 0
    v_mfma_f32_32x32x16_bf16 v[208:223], v[84:87], v[36:39], v[208:223]
    v_mfma_f32_32x32x16_bf16 v[208:223], v[88:91], v[40:43], v[208:223]
    v_mfma_f32_32x32x16_bf16 v[208:223], v[92:95], v[44:47], v[208:223]
    s_waitcnt vmcnt(4)
    v_mfma_f32_32x32x16_bf16 v[224:239], v[96:99], v[32:35], 0
    v_mfma_f32_32x32x16_bf16 v[224:239], v[100:103], v[36:39], v[224:239]
    v_mfma_f32_32x32x16_bf16 v[224:239], v[104:107], v[40:43], v[224:239]
    v_mfma_f32_32x32x16_bf16 v[224:239], v[108:111], v[44:47], v[224:239]
    s_add_u32 s61, s68, 4096
    buffer_load_dwordx4 v[128:131], v2, s[44:47], s61 offen offset:0 sc1
    buffer_load_dwordx4 v[132:135], v2, s[44:47], s61 offen offset:1024 sc1
    buffer_load_dwordx4 v[136:139], v2, s[44:47], s61 offen offset:2048 sc1
    buffer_load_dwordx4 v[140:143], v2, s[44:47], s61 offen offset:3072 sc1
    s_waitcnt vmcnt(4)
    v_mfma_f32_32x32x16_bf16 v[240:255], v[112:115], v[32:35], 0
    v_mfma_f32_32x32x16_bf16 v[240:255], v[116:119], v[36:39], v[240:255]
    v_mfma_f32_32x32x16_bf16 v[240:255], v[120:123], v[40:43], v[240:255]
    v_mfma_f32_32x32x16_bf16 v[240:255], v[124:127], v[44:47], v[240:255]
    s_add_u32 s61, s68, 12288
    buffer_load_dwordx4 v[144:147], v2, s[44:47], s61 offen offset:0 sc1
    buffer_load_dwordx4 v[148:151], v2, s[44:47], s61 offen offset:1024 sc1
    buffer_load_dwordx4 v[152:155], v2, s[44:47], s61 offen offset:2048 sc1
    buffer_load_dwordx4 v[156:159], v2, s[44:47], s61 offen offset:3072 sc1
    v_max3_f32 v12, v192, v193, v194
    v_max_f32 v13, v195, v196
    v_max3_f32 v12, v12, v197, v198
    v_max3_f32 v13, v13, v199, v200
    v_max3_f32 v12, v12, v201, v202
    v_max3_f32 v13, v13, v203, v204
    v_max3_f32 v12, v12, v205, v206
    v_max3_f32 v13, v13, v207, v208
    v_max3_f32 v12, v12, v209, v210
    v_max3_f32 v13, v13, v211, v212
    v_max3_f32 v12, v12, v213, v214
    v_max3_f32 v13, v13, v215, v216
    v_max3_f32 v12, v12, v217, v218
    v_max3_f32 v13, v13, v219, v220
    v_max3_f32 v12, v12, v221, v222
    v_max3_f32 v13, v13, v223, v224
    v_max3_f32 v12, v12, v225, v226
    v_max3_f32 v13, v13, v227, v228
    v_max3_f32 v12, v12, v229, v230
    v_max3_f32 v13, v13, v231, v232
    v_max3_f32 v12, v12, v233, v234
    v_max3_f32 v13, v13, v235, v236
    s_cmp_lg_u32 s60, 7
    s_cbranch_scc1 L_36
    v_mov_b32 v244, 0xff800000
    v_mov_b32 v245, 0xff800000
    v_mov_b32 v246, 0xff800000
    v_mov_b32 v247, 0xff800000
    v_mov_b32 v248, 0xff800000
    v_mov_b32 v249, 0xff800000
    v_mov_b32 v250, 0xff800000
    v_mov_b32 v251, 0xff800000
    v_mov_b32 v252, 0xff800000
    v_mov_b32 v253, 0xff800000
    v_mov_b32 v254, 0xff800000
    v_mov_b32 v255, 0xff800000
L_36:
    v_max3_f32 v12, v12, v237, v238
    v_max3_f32 v13, v13, v239, v240
    v_max3_f32 v12, v12, v241, v242
    v_max3_f32 v13, v13, v243, v244
    v_max3_f32 v12, v12, v245, v246
    v_max3_f32 v13, v13, v247, v248
    v_max3_f32 v12, v12, v249, v250
    v_max3_f32 v13, v13, v251, v252
    v_max3_f32 v12, v12, v253, v254
    v_max3_f32 v12, v12, v13, v255
    v_mov_b32 v13, v12
    s_mov_b32 s6, 0x3e38aa3b
    s_mov_b32 s7, 0x3e38aa3b
    v_permlane32_swap_b32 v12, v13
    v_max_f32 v12, v12, v13
    v_mul_f32 v14, s6, v12
    s_add_u32 s61, s68, 20480
    buffer_load_dwordx4 v[160:163], v2, s[44:47], s61 offen offset:0 sc1
    buffer_load_dwordx4 v[164:167], v2, s[44:47], s61 offen offset:1024 sc1
    buffer_load_dwordx4 v[168:171], v2, s[44:47], s61 offen offset:2048 sc1
    buffer_load_dwordx4 v[172:175], v2, s[44:47], s61 offen offset:3072 sc1
    s_add_u32 s61, s68, 28672
    buffer_load_dwordx4 v[176:179], v2, s[44:47], s61 offen offset:0 sc1
    buffer_load_dwordx4 v[180:183], v2, s[44:47], s61 offen offset:1024 sc1
    buffer_load_dwordx4 v[184:187], v2, s[44:47], s61 offen offset:2048 sc1
    buffer_load_dwordx4 v[188:191], v2, s[44:47], s61 offen offset:3072 sc1
    s_setprio 0
    v_pk_fma_f32 v[192:193], v[192:193], s[6:7], v[14:15] op_sel_hi:[1,1,0] neg_lo:[0,0,1] neg_hi:[0,0,1]
    v_pk_fma_f32 v[194:195], v[194:195], s[6:7], v[14:15] op_sel_hi:[1,1,0] neg_lo:[0,0,1] neg_hi:[0,0,1]
    v_pk_fma_f32 v[196:197], v[196:197], s[6:7], v[14:15] op_sel_hi:[1,1,0] neg_lo:[0,0,1] neg_hi:[0,0,1]
    v_pk_fma_f32 v[198:199], v[198:199], s[6:7], v[14:15] op_sel_hi:[1,1,0] neg_lo:[0,0,1] neg_hi:[0,0,1]
    v_pk_fma_f32 v[200:201], v[200:201], s[6:7], v[14:15] op_sel_hi:[1,1,0] neg_lo:[0,0,1] neg_hi:[0,0,1]
    v_pk_fma_f32 v[202:203], v[202:203], s[6:7], v[14:15] op_sel_hi:[1,1,0] neg_lo:[0,0,1] neg_hi:[0,0,1]
    v_pk_fma_f32 v[204:205], v[204:205], s[6:7], v[14:15] op_sel_hi:[1,1,0] neg_lo:[0,0,1] neg_hi:[0,0,1]
    v_pk_fma_f32 v[206:207], v[206:207], s[6:7], v[14:15] op_sel_hi:[1,1,0] neg_lo:[0,0,1] neg_hi:[0,0,1]
    v_exp_f32 v192, v192
    v_exp_f32 v193, v193
    v_exp_f32 v194, v194
    v_exp_f32 v195, v195
    v_exp_f32 v196, v196
    v_exp_f32 v197, v197
    v_exp_f32 v198, v198
    v_exp_f32 v199, v199
    v_exp_f32 v200, v200
    v_exp_f32 v201, v201
    v_exp_f32 v202, v202
    v_exp_f32 v203, v203
    v_exp_f32 v204, v204
    v_exp_f32 v205, v205
    v_exp_f32 v206, v206
    v_exp_f32 v207, v207
    v_pk_add_f32 v[12:13], v[192:193], v[194:195]
    v_pk_add_f32 v[12:13], v[12:13], v[196:197]
    v_pk_add_f32 v[12:13], v[12:13], v[198:199]
    v_pk_add_f32 v[12:13], v[12:13], v[200:201]
    v_pk_add_f32 v[12:13], v[12:13], v[202:203]
    v_pk_add_f32 v[12:13], v[12:13], v[204:205]
    v_pk_add_f32 v[12:13], v[12:13], v[206:207]
    v_cvt_pk_bf16_f32 v192, v192, v193
    v_cvt_pk_bf16_f32 v193, v194, v195
    v_cvt_pk_bf16_f32 v194, v196, v197
    v_cvt_pk_bf16_f32 v195, v198, v199
    v_cvt_pk_bf16_f32 v196, v200, v201
    v_cvt_pk_bf16_f32 v197, v202, v203
    v_cvt_pk_bf16_f32 v198, v204, v205
    v_cvt_pk_bf16_f32 v199, v206, v207
    s_waitcnt vmcnt(12)
    v_mfma_f32_32x32x16_bf16 v[32:47], v[128:131], v[192:195], 0
    v_mfma_f32_32x32x16_bf16 v[48:63], v[136:139], v[192:195], 0
    v_mfma_f32_32x32x16_bf16 v[32:47], v[132:135], v[196:199], v[32:47]
    v_mfma_f32_32x32x16_bf16 v[48:63], v[140:143], v[196:199], v[48:63]
    v_pk_fma_f32 v[208:209], v[208:209], s[6:7], v[14:15] op_sel_hi:[1,1,0] neg_lo:[0,0,1] neg_hi:[0,0,1]
    v_pk_fma_f32 v[210:211], v[210:211], s[6:7], v[14:15] op_sel_hi:[1,1,0] neg_lo:[0,0,1] neg_hi:[0,0,1]
    v_pk_fma_f32 v[212:213], v[212:213], s[6:7], v[14:15] op_sel_hi:[1,1,0] neg_lo:[0,0,1] neg_hi:[0,0,1]
    v_pk_fma_f32 v[214:215], v[214:215], s[6:7], v[14:15] op_sel_hi:[1,1,0] neg_lo:[0,0,1] neg_hi:[0,0,1]
    v_pk_fma_f32 v[216:217], v[216:217], s[6:7], v[14:15] op_sel_hi:[1,1,0] neg_lo:[0,0,1] neg_hi:[0,0,1]
    v_pk_fma_f32 v[218:219], v[218:219], s[6:7], v[14:15] op_sel_hi:[1,1,0] neg_lo:[0,0,1] neg_hi:[0,0,1]
    v_pk_fma_f32 v[220:221], v[220:221], s[6:7], v[14:15] op_sel_hi:[1,1,0] neg_lo:[0,0,1] neg_hi:[0,0,1]
    v_pk_fma_f32 v[222:223], v[222:223], s[6:7], v[14:15] op_sel_hi:[1,1,0] neg_lo:[0,0,1] neg_hi:[0,0,1]
    v_exp_f32 v208, v208
    v_exp_f32 v209, v209
    v_exp_f32 v210, v210
    v_exp_f32 v211, v211
    v_exp_f32 v212, v212
    v_exp_f32 v213, v213
    v_exp_f32 v214, v214
    v_exp_f32 v215, v215
    v_exp_f32 v216, v216
    v_exp_f32 v217, v217
    v_exp_f32 v218, v218
    v_exp_f32 v219, v219
    v_exp_f32 v220, v220
    v_exp_f32 v221, v221
    v_exp_f32 v222, v222
    v_exp_f32 v223, v223
    v_pk_add_f32 v[12:13], v[12:13], v[208:209]
    v_pk_add_f32 v[12:13], v[12:13], v[210:211]
    v_pk_add_f32 v[12:13], v[12:13], v[212:213]
    v_pk_add_f32 v[12:13], v[12:13], v[214:215]
    v_pk_add_f32 v[12:13], v[12:13], v[216:217]
    v_pk_add_f32 v[12:13], v[12:13], v[218:219]
    v_pk_add_f32 v[12:13], v[12:13], v[220:221]
    v_pk_add_f32 v[12:13], v[12:13], v[222:223]
    v_cvt_pk_bf16_f32 v208, v208, v209
    v_cvt_pk_bf16_f32 v209, v210, v211
    v_cvt_pk_bf16_f32 v210, v212, v213
    v_cvt_pk_bf16_f32 v211, v214, v215
    v_cvt_pk_bf16_f32 v212, v216, v217
    v_cvt_pk_bf16_f32 v213, v218, v219
    v_cvt_pk_bf16_f32 v214, v220, v221
    v_cvt_pk_bf16_f32 v215, v222, v223
    s_waitcnt vmcnt(8)
    v_mfma_f32_32x32x16_bf16 v[32:47], v[144:147], v[208:211], v[32:47]
    v_mfma_f32_32x32x16_bf16 v[48:63], v[152:155], v[208:211], v[48:63]
    v_mfma_f32_32x32x16_bf16 v[32:47], v[148:151], v[212:215], v[32:47]
    v_mfma_f32_32x32x16_bf16 v[48:63], v[156:159], v[212:215], v[48:63]
    v_pk_fma_f32 v[224:225], v[224:225], s[6:7], v[14:15] op_sel_hi:[1,1,0] neg_lo:[0,0,1] neg_hi:[0,0,1]
    v_pk_fma_f32 v[226:227], v[226:227], s[6:7], v[14:15] op_sel_hi:[1,1,0] neg_lo:[0,0,1] neg_hi:[0,0,1]
    v_pk_fma_f32 v[228:229], v[228:229], s[6:7], v[14:15] op_sel_hi:[1,1,0] neg_lo:[0,0,1] neg_hi:[0,0,1]
    v_pk_fma_f32 v[230:231], v[230:231], s[6:7], v[14:15] op_sel_hi:[1,1,0] neg_lo:[0,0,1] neg_hi:[0,0,1]
    v_pk_fma_f32 v[232:233], v[232:233], s[6:7], v[14:15] op_sel_hi:[1,1,0] neg_lo:[0,0,1] neg_hi:[0,0,1]
    v_pk_fma_f32 v[234:235], v[234:235], s[6:7], v[14:15] op_sel_hi:[1,1,0] neg_lo:[0,0,1] neg_hi:[0,0,1]
    v_pk_fma_f32 v[236:237], v[236:237], s[6:7], v[14:15] op_sel_hi:[1,1,0] neg_lo:[0,0,1] neg_hi:[0,0,1]
    v_pk_fma_f32 v[238:239], v[238:239], s[6:7], v[14:15] op_sel_hi:[1,1,0] neg_lo:[0,0,1] neg_hi:[0,0,1]
    v_exp_f32 v224, v224
    v_exp_f32 v225, v225
    v_exp_f32 v226, v226
    v_exp_f32 v227, v227
    v_exp_f32 v228, v228
    v_exp_f32 v229, v229
    v_exp_f32 v230, v230
    v_exp_f32 v231, v231
    v_exp_f32 v232, v232
    v_exp_f32 v233, v233
    v_exp_f32 v234, v234
    v_exp_f32 v235, v235
    v_exp_f32 v236, v236
    v_exp_f32 v237, v237
    v_exp_f32 v238, v238
    v_exp_f32 v239, v239
    v_pk_add_f32 v[12:13], v[12:13], v[224:225]
    v_pk_add_f32 v[12:13], v[12:13], v[226:227]
    v_pk_add_f32 v[12:13], v[12:13], v[228:229]
    v_pk_add_f32 v[12:13], v[12:13], v[230:231]
    v_pk_add_f32 v[12:13], v[12:13], v[232:233]
    v_pk_add_f32 v[12:13], v[12:13], v[234:235]
    v_pk_add_f32 v[12:13], v[12:13], v[236:237]
    v_pk_add_f32 v[12:13], v[12:13], v[238:239]
    v_cvt_pk_bf16_f32 v224, v224, v225
    v_cvt_pk_bf16_f32 v225, v226, v227
    v_cvt_pk_bf16_f32 v226, v228, v229
    v_cvt_pk_bf16_f32 v227, v230, v231
    v_cvt_pk_bf16_f32 v228, v232, v233
    v_cvt_pk_bf16_f32 v229, v234, v235
    v_cvt_pk_bf16_f32 v230, v236, v237
    v_cvt_pk_bf16_f32 v231, v238, v239
    s_waitcnt vmcnt(4)
    v_mfma_f32_32x32x16_bf16 v[32:47], v[160:163], v[224:227], v[32:47]
    v_mfma_f32_32x32x16_bf16 v[48:63], v[168:171], v[224:227], v[48:63]
    v_mfma_f32_32x32x16_bf16 v[32:47], v[164:167], v[228:231], v[32:47]
    v_mfma_f32_32x32x16_bf16 v[48:63], v[172:175], v[228:231], v[48:63]
    v_pk_fma_f32 v[240:241], v[240:241], s[6:7], v[14:15] op_sel_hi:[1,1,0] neg_lo:[0,0,1] neg_hi:[0,0,1]
    v_pk_fma_f32 v[242:243], v[242:243], s[6:7], v[14:15] op_sel_hi:[1,1,0] neg_lo:[0,0,1] neg_hi:[0,0,1]
    v_pk_fma_f32 v[244:245], v[244:245], s[6:7], v[14:15] op_sel_hi:[1,1,0] neg_lo:[0,0,1] neg_hi:[0,0,1]
    v_pk_fma_f32 v[246:247], v[246:247], s[6:7], v[14:15] op_sel_hi:[1,1,0] neg_lo:[0,0,1] neg_hi:[0,0,1]
    v_pk_fma_f32 v[248:249], v[248:249], s[6:7], v[14:15] op_sel_hi:[1,1,0] neg_lo:[0,0,1] neg_hi:[0,0,1]
    v_pk_fma_f32 v[250:251], v[250:251], s[6:7], v[14:15] op_sel_hi:[1,1,0] neg_lo:[0,0,1] neg_hi:[0,0,1]
    v_pk_fma_f32 v[252:253], v[252:253], s[6:7], v[14:15] op_sel_hi:[1,1,0] neg_lo:[0,0,1] neg_hi:[0,0,1]
    v_pk_fma_f32 v[254:255], v[254:255], s[6:7], v[14:15] op_sel_hi:[1,1,0] neg_lo:[0,0,1] neg_hi:[0,0,1]
    v_exp_f32 v240, v240
    v_exp_f32 v241, v241
    v_exp_f32 v242, v242
    v_exp_f32 v243, v243
    v_exp_f32 v244, v244
    v_exp_f32 v245, v245
    s_add_u32 s74, s70, 9445376
    buffer_load_dwordx4 v[96:99], v2, s[44:47], s74 offen offset:0 sc1
    v_exp_f32 v246, v246
    v_exp_f32 v247, v247
    v_exp_f32 v248, v248
    v_exp_f32 v249, v249
    v_exp_f32 v250, v250
    v_exp_f32 v251, v251
    v_exp_f32 v252, v252
    v_exp_f32 v253, v253
    v_exp_f32 v254, v254
    v_exp_f32 v255, v255
    buffer_load_dwordx4 v[100:103], v2, s[44:47], s74 offen offset:1024 sc1
    v_pk_add_f32 v[12:13], v[12:13], v[240:241]
    v_pk_add_f32 v[12:13], v[12:13], v[242:243]
    v_pk_add_f32 v[12:13], v[12:13], v[244:245]
    v_pk_add_f32 v[12:13], v[12:13], v[246:247]
    v_pk_add_f32 v[12:13], v[12:13], v[248:249]
    v_pk_add_f32 v[12:13], v[12:13], v[250:251]
    v_pk_add_f32 v[12:13], v[12:13], v[252:253]
    v_pk_add_f32 v[12:13], v[12:13], v[254:255]
    v_cvt_pk_bf16_f32 v240, v240, v241
    v_cvt_pk_bf16_f32 v241, v242, v243
    v_cvt_pk_bf16_f32 v242, v244, v245
    v_cvt_pk_bf16_f32 v243, v246, v247
    v_cvt_pk_bf16_f32 v244, v248, v249
    v_cvt_pk_bf16_f32 v245, v250, v251
    v_cvt_pk_bf16_f32 v246, v252, v253
    v_cvt_pk_bf16_f32 v247, v254, v255
    s_waitcnt vmcnt(2)
    v_mfma_f32_32x32x16_bf16 v[32:47], v[176:179], v[240:243], v[32:47]
    buffer_load_dwordx4 v[104:107], v2, s[44:47], s74 offen offset:2048 sc1
    v_mfma_f32_32x32x16_bf16 v[48:63], v[184:187], v[240:243], v[48:63]
    v_mfma_f32_32x32x16_bf16 v[32:47], v[180:183], v[244:247], v[32:47]
    v_mfma_f32_32x32x16_bf16 v[48:63], v[188:191], v[244:247], v[48:63]
    buffer_load_dwordx4 v[108:111], v2, s[44:47], s74 offen offset:3072 sc1
    v_add_f32 v13, v12, v13
    v_mov_b32 v15, v13
    v_cmp_gt_u32 vcc, 32, v1
    s_nop 0
    v_permlane32_swap_b32 v13, v15
    v_add_f32 v13, v13, v15
    v_cndmask_b32 v13, v13, v14, vcc
    ds_write_b32 v9, v13 offset:8192
    s_add_u32 s61, s72, 65536
    v_add_u32 v12, s61, v2
    ds_write_b128 v12, v[32:35] offset:0
    ds_write_b128 v12, v[36:39] offset:1024
    ds_write_b128 v12, v[40:43] offset:2048
    ds_write_b128 v12, v[44:47] offset:3072
    ds_write_b128 v12, v[48:51] offset:4096
    ds_write_b128 v12, v[52:55] offset:5120
    ds_write_b128 v12, v[56:59] offset:6144
    ds_write_b128 v12, v[60:63] offset:7168
    s_add_u32 s74, s70, 9449472
    buffer_load_dwordx4 v[112:115], v2, s[44:47], s74 offen offset:0 sc1
    buffer_load_dwordx4 v[116:119], v2, s[44:47], s74 offen offset:1024 sc1
    buffer_load_dwordx4 v[120:123], v2, s[44:47], s74 offen offset:2048 sc1
    buffer_load_dwordx4 v[124:127], v2, s[44:47], s74 offen offset:3072 sc1
    s_waitcnt lgkmcnt(0)
    s_barrier
    s_cmp_ge_u32 s60, 4
    s_cbranch_scc1 L_37
    v_and_b32 v12, 31, v1
    v_lshlrev_b32 v12, 2, v12
    v_add_u32 v12, 155648, v12
    v_add_u32 v13, 128, v12
    ds_read2st64_b32 v[48:49], v12 offset0:0 offset1:1
    ds_read2st64_b32 v[50:51], v12 offset0:2 offset1:3
    ds_read2st64_b32 v[52:53], v12 offset0:4 offset1:5
    ds_read2st64_b32 v[54:55], v12 offset0:6 offset1:7
    ds_read2st64_b32 v[56:57], v13 offset0:0 offset1:1
    ds_read2st64_b32 v[58:59], v13 offset0:2 offset1:3
    ds_read2st64_b32 v[60:61], v13 offset0:4 offset1:5
    ds_read2st64_b32 v[62:63], v13 offset0:6 offset1:7
    v_add_u32 v14, -65536, v7
    ds_read_b128 v[128:131], v14 offset:0
    ds_read_b128 v[132:135], v14 offset:1024
    ds_read_b128 v[136:139], v14 offset:8192
    ds_read_b128 v[140:143], v14 offset:9216
    ds_read_b128 v[144:147], v14 offset:16384
    ds_read_b128 v[148:151], v14 offset:17408
    ds_read_b128 v[152:155], v14 offset:24576
    ds_read_b128 v[156:159], v14 offset:25600
    ds_read_b128 v[160:163], v14 offset:32768
    ds_read_b128 v[164:167], v14 offset:33792
    ds_read_b128 v[168:171], v14 offset:40960
    ds_read_b128 v[172:175], v14 offset:41984
    ds_read_b128 v[176:179], v14 offset:49152
    ds_read_b128 v[180:183], v14 offset:50176
    ds_read_b128 v[184:187], v14 offset:57344
    ds_read_b128 v[188:191], v14 offset:58368
    s_waitcnt lgkmcnt(15)
    v_max3_f32 v12, v48, v49, v50
    v_max3_f32 v13, v51, v52, v53
    v_max3_f32 v12, v12, v54, v55
    v_max_f32 v12, v12, v13
    v_pk_add_f32 v[48:49], v[48:49], v[12:13] op_sel_hi:[1,0] neg_lo:[0,1] neg_hi:[0,1]
    v_pk_add_f32 v[50:51], v[50:51], v[12:13] op_sel_hi:[1,0] neg_lo:[0,1] neg_hi:[0,1]
    v_pk_add_f32 v[52:53], v[52:53], v[12:13] op_sel_hi:[1,0] neg_lo:[0,1] neg_hi:[0,1]
    v_pk_add_f32 v[54:55], v[54:55], v[12:13] op_sel_hi:[1,0] neg_lo:[0,1] neg_hi:[0,1]
    v_exp_f32 v48, v48
    v_exp_f32 v49, v49
    v_exp_f32 v50, v50
    v_exp_f32 v51, v51
    v_exp_f32 v52, v52
    v_exp_f32 v53, v53
    v_exp_f32 v54, v54
    v_exp_f32 v55, v55
    v_pk_mul_f32 v[12:13], v[48:49], v[56:57]
    v_pk_fma_f32 v[12:13], v[50:51], v[58:59], v[12:13]
    v_pk_fma_f32 v[12:13], v[52:53], v[60:61], v[12:13]
    v_pk_fma_f32 v[12:13], v[54:55], v[62:63], v[12:13]
    v_add_f32 v12, v12, v13
    v_rcp_f32 v12, v12
    s_waitcnt lgkmcnt(0)
    v_pk_mul_f32 v[32:33], v[128:129], v[48:49] op_sel_hi:[1,0]
    v_pk_mul_f32 v[34:35], v[130:131], v[48:49] op_sel_hi:[1,0]
    v_pk_mul_f32 v[36:37], v[132:133], v[48:49] op_sel_hi:[1,0]
    v_pk_mul_f32 v[38:39], v[134:135], v[48:49] op_sel_hi:[1,0]
    v_pk_fma_f32 v[32:33], v[136:137], v[48:49], v[32:33] op_sel:[0,1,0] op_sel_hi:[1,1,1]
    v_pk_fma_f32 v[34:35], v[138:139], v[48:49], v[34:35] op_sel:[0,1,0] op_sel_hi:[1,1,1]
    v_pk_fma_f32 v[36:37], v[140:141], v[48:49], v[36:37] op_sel:[0,1,0] op_sel_hi:[1,1,1]
    v_pk_fma_f32 v[38:39], v[142:143], v[48:49], v[38:39] op_sel:[0,1,0] op_sel_hi:[1,1,1]
    v_pk_fma_f32 v[32:33], v[144:145], v[50:51], v[32:33] op_sel_hi:[1,0,1]
    v_pk_fma_f32 v[34:35], v[146:147], v[50:51], v[34:35] op_sel_hi:[1,0,1]
    v_pk_fma_f32 v[36:37], v[148:149], v[50:51], v[36:37] op_sel_hi:[1,0,1]
    v_pk_fma_f32 v[38:39], v[150:151], v[50:51], v[38:39] op_sel_hi:[1,0,1]
    v_pk_fma_f32 v[32:33], v[152:153], v[50:51], v[32:33] op_sel:[0,1,0] op_sel_hi:[1,1,1]
    v_pk_fma_f32 v[34:35], v[154:155], v[50:51], v[34:35] op_sel:[0,1,0] op_sel_hi:[1,1,1]
    v_pk_fma_f32 v[36:37], v[156:157], v[50:51], v[36:37] op_sel:[0,1,0] op_sel_hi:[1,1,1]
    v_pk_fma_f32 v[38:39], v[158:159], v[50:51], v[38:39] op_sel:[0,1,0] op_sel_hi:[1,1,1]
    v_pk_fma_f32 v[32:33], v[160:161], v[52:53], v[32:33] op_sel_hi:[1,0,1]
    v_pk_fma_f32 v[34:35], v[162:163], v[52:53], v[34:35] op_sel_hi:[1,0,1]
    v_pk_fma_f32 v[36:37], v[164:165], v[52:53], v[36:37] op_sel_hi:[1,0,1]
    v_pk_fma_f32 v[38:39], v[166:167], v[52:53], v[38:39] op_sel_hi:[1,0,1]
    v_pk_fma_f32 v[32:33], v[168:169], v[52:53], v[32:33] op_sel:[0,1,0] op_sel_hi:[1,1,1]
    v_pk_fma_f32 v[34:35], v[170:171], v[52:53], v[34:35] op_sel:[0,1,0] op_sel_hi:[1,1,1]
    v_pk_fma_f32 v[36:37], v[172:173], v[52:53], v[36:37] op_sel:[0,1,0] op_sel_hi:[1,1,1]
    v_pk_fma_f32 v[38:39], v[174:175], v[52:53], v[38:39] op_sel:[0,1,0] op_sel_hi:[1,1,1]
    v_pk_fma_f32 v[32:33], v[176:177], v[54:55], v[32:33] op_sel_hi:[1,0,1]
    v_pk_fma_f32 v[34:35], v[178:179], v[54:55], v[34:35] op_sel_hi:[1,0,1]
    v_pk_fma_f32 v[36:37], v[180:181], v[54:55], v[36:37] op_sel_hi:[1,0,1]
    v_pk_fma_f32 v[38:39], v[182:183], v[54:55], v[38:39] op_sel_hi:[1,0,1]
    v_pk_fma_f32 v[32:33], v[184:185], v[54:55], v[32:33] op_sel:[0,1,0] op_sel_hi:[1,1,1]
    v_pk_fma_f32 v[34:35], v[186:187], v[54:55], v[34:35] op_sel:[0,1,0] op_sel_hi:[1,1,1]
    v_pk_fma_f32 v[36:37], v[188:189], v[54:55], v[36:37] op_sel:[0,1,0] op_sel_hi:[1,1,1]
    v_pk_fma_f32 v[38:39], v[190:191], v[54:55], v[38:39] op_sel:[0,1,0] op_sel_hi:[1,1,1]
    v_pk_mul_f32 v[32:33], v[32:33], v[12:13] op_sel_hi:[1,0]
    v_pk_mul_f32 v[34:35], v[34:35], v[12:13] op_sel_hi:[1,0]
    v_pk_mul_f32 v[36:37], v[36:37], v[12:13] op_sel_hi:[1,0]
    v_pk_mul_f32 v[38:39], v[38:39], v[12:13] op_sel_hi:[1,0]
    v_cvt_pk_bf16_f32 v56, v32, v33
    v_cvt_pk_bf16_f32 v57, v34, v35
    v_cvt_pk_bf16_f32 v58, v36, v37
    v_cvt_pk_bf16_f32 v59, v38, v39
    v_pk_add_f32 v[12:13], v[32:33], v[34:35]
    v_pk_add_f32 v[14:15], v[36:37], v[38:39]
    v_pk_add_f32 v[12:13], v[12:13], v[14:15]
    v_cmp_u_f32 vcc, v12, v13
    s_cmp_eq_u32 s35, 0
    s_nop 0
    s_cselect_b64 vcc, 0, vcc
    s_cmp_lg_u64 vcc, 0
    s_cbranch_scc1 L_38
    s_add_u32 s61, s67, 6291456
    s_cmp_eq_u32 s65, 0
    s_cbranch_scc1 L_39
    buffer_store_dwordx4 v[56:59], v2, s[44:47], s61 offen
    s_branch L_40
L_39:
    buffer_store_dwordx4 v[56:59], v2, s[44:47], s61 offen sc1
L_40:
    s_and_b32 s61, s61, 0x3fff
    v_add_u32 v12, s61, v8
    ds_write_b128 v12, v[56:59]
    s_branch L_37
L_38:
    v_mov_b32 v12, 160768
    v_mov_b32 v13, s35
    ds_write_b32 v12, v13
L_37:
    s_nop 1
    s_waitcnt lgkmcnt(0)
    s_barrier
    v_mov_b32 v12, 160768
    ds_read_b32 v13, v12
    s_waitcnt lgkmcnt(0)
    v_readfirstlane_b32 s61, v13
    s_nop 1
    s_cmp_eq_u32 s61, s35
    s_cselect_b32 s61, 1, 0
    s_sub_u32 s35, s35, s61
    s_cmp_lg_u32 s61, 0
    s_cbranch_scc1 L_att
    s_cmp_lt_u32 s60, 4
    s_cbranch_scc1 L_41
    s_add_u32 s61, s67, 6287360
    s_xor_b32 s62, s61, 0x1000
    s_xor_b32 s63, s61, 0x2000
    s_xor_b32 s3, s61, 0x3000
    s_movk_i32 s4, 0x4000
    s_nop 1
P_42:
    buffer_load_dwordx4 v[128:131], v2, s[44:47], s62 offen sc1
    buffer_load_dwordx4 v[132:135], v2, s[44:47], s63 offen sc1
    buffer_load_dwordx4 v[136:139], v2, s[44:47], s3 offen sc1
    s_waitcnt vmcnt(0)
    v_max_u32 v12, v128, v129
    v_max3_u32 v12, v12, v130, v131
    v_max3_u32 v12, v12, v132, v133
    v_max3_u32 v12, v12, v134, v135
    v_max3_u32 v12, v12, v136, v137
    v_max3_u32 v12, v12, v138, v139
    v_cmp_eq_u32 vcc, -1, v12
    s_nop 1
    s_cbranch_vccz D_43
    s_sleep 1
    s_sub_u32 s4, s4, 1
    s_cbranch_scc0 P_42
D_43:
    s_nop 1
    s_and_b32 s62, s62, 0x3fff
    v_add_u32 v12, s62, v8
    ds_write_b128 v12, v[128:131]
    s_and_b32 s63, s63, 0x3fff
    v_add_u32 v12, s63, v8
    ds_write_b128 v12, v[132:135]
    s_and_b32 s3, s3, 0x3fff
    v_add_u32 v12, s3, v8
    ds_write_b128 v12, v[136:139]
L_41:
    s_waitcnt lgkmcnt(0)
    s_barrier
    v_lshrrev_b32 v5, 3, v1
    v_mul_u32_u24 v5, 1024, v5
    v_add_u32 v5, v5, v6
    v_xor_b32 v5, s54, v5
    v_add_u32 v15, s72, v2
    ds_read_b128 v[192:195], v8 offset:0
    ds_read_b128 v[196:199], v15 offset:0
    ds_read_b128 v[200:203], v8 offset:1024
    ds_read_b128 v[204:207], v15 offset:1024
    ds_read_b128 v[208:211], v8 offset:2048
    ds_read_b128 v[212:215], v15 offset:2048
    ds_read_b128 v[216:219], v8 offset:3072
    ds_read_b128 v[220:223], v15 offset:3072
    ds_read_b128 v[224:227], v8 offset:4096
    ds_read_b128 v[228:231], v15 offset:4096
    s_waitcnt lgkmcnt(8)
    v_mfma_f32_32x32x16_bf16 v[32:47], v[196:199], v[192:195], 0
    ds_read_b128 v[232:235], v8 offset:5120
    ds_read_b128 v[236:239], v15 offset:5120
    s_waitcnt lgkmcnt(8)
    v_mfma_f32_32x32x16_bf16 v[32:47], v[204:207], v[200:203], v[32:47]
    ds_read_b128 v[192:195], v8 offset:6144
    ds_read_b128 v[196:199], v15 offset:6144
    s_waitcnt lgkmcnt(8)
    v_mfma_f32_32x32x16_bf16 v[32:47], v[212:215], v[208:211], v[32:47]
    ds_read_b128 v[200:203], v8 offset:7168
    ds_read_b128 v[204:207], v15 offset:7168
    s_waitcnt lgkmcnt(8)
    v_mfma_f32_32x32x16_bf16 v[32:47], v[220:223], v[216:219], v[32:47]
    s_waitcnt lgkmcnt(6)
    v_mfma_f32_32x32x16_bf16 v[32:47], v[228:231], v[224:227], v[32:47]
    s_waitcnt lgkmcnt(4)
    v_mfma_f32_32x32x16_bf16 v[32:47], v[236:239], v[232:235], v[32:47]
    s_waitcnt lgkmcnt(2)
    v_mfma_f32_32x32x16_bf16 v[32:47], v[196:199], v[192:195], v[32:47]
    s_waitcnt lgkmcnt(0)
    v_mfma_f32_32x32x16_bf16 v[32:47], v[204:207], v[200:203], v[32:47]
    s_waitcnt vmcnt(0)
    s_barrier
    ds_read_b128 v[64:67], v8 offset:8192
    ds_read_b128 v[68:71], v8 offset:9216
    ds_read_b128 v[72:75], v8 offset:10240
    ds_read_b128 v[76:79], v8 offset:11264
    ds_read_b128 v[80:83], v8 offset:12288
    s_waitcnt lgkmcnt(4)
    v_mfma_f32_32x32x16_bf16 v[32:47], v[96:99], v[64:67], v[32:47]
    ds_read_b128 v[84:87], v8 offset:13312
    s_add_u32 m0, s72, 0
    s_add_u32 s75, s53, 0
    buffer_load_dwordx4 v5, s[76:79], s75 offen lds
    s_waitcnt lgkmcnt(4)
    v_mfma_f32_32x32x16_bf16 v[32:47], v[100:103], v[68:71], v[32:47]
    ds_read_b128 v[64:67], v8 offset:14336
    s_add_u32 m0, s72, 1024
    s_add_u32 s75, s53, 8192
    buffer_load_dwordx4 v5, s[76:79], s75 offen lds
    s_waitcnt lgkmcnt(4)
    v_mfma_f32_32x32x16_bf16 v[32:47], v[104:107], v[72:75], v[32:47]
    ds_read_b128 v[68:71], v8 offset:15360
    s_add_u32 m0, s72, 2048
    s_add_u32 s75, s53, 16384
    buffer_load_dwordx4 v5, s[76:79], s75 offen lds
    s_waitcnt lgkmcnt(4)
    v_mfma_f32_32x32x16_bf16 v[32:47], v[108:111], v[76:79], v[32:47]
    s_add_u32 m0, s72, 3072
    s_add_u32 s75, s53, 24576
    buffer_load_dwordx4 v5, s[76:79], s75 offen lds
    s_waitcnt lgkmcnt(3)
    v_mfma_f32_32x32x16_bf16 v[32:47], v[112:115], v[80:83], v[32:47]
    s_add_u32 m0, s72, 4096
    s_add_u32 s75, s53, 32768
    buffer_load_dwordx4 v5, s[76:79], s75 offen lds
    s_waitcnt lgkmcnt(2)
    v_mfma_f32_32x32x16_bf16 v[32:47], v[116:119], v[84:87], v[32:47]
    s_add_u32 m0, s72, 5120
    s_add_u32 s75, s53, 40960
    buffer_load_dwordx4 v5, s[76:79], s75 offen lds
    s_waitcnt lgkmcnt(1)
    v_mfma_f32_32x32x16_bf16 v[32:47], v[120:123], v[64:67], v[32:47]
    s_add_u32 m0, s72, 6144
    s_add_u32 s75, s53, 49152
    buffer_load_dwordx4 v5, s[76:79], s75 offen lds
    s_waitcnt lgkmcnt(0)
    v_mfma_f32_32x32x16_bf16 v[32:47], v[124:127], v[68:71], v[32:47]
    s_add_u32 m0, s72, 7168
    s_add_u32 s75, s53, 57344
    buffer_load_dwordx4 v5, s[76:79], s75 offen lds
    v_lshrrev_b32 v5, 3, v1
    v_mul_u32_u24 v5, 2048, v5
    v_add_u32 v5, v5, v6
    s_and_b32 s3, s60, 1
    v_and_b32 v6, 0x3ff, v3
    s_lshl_b32 s3, s3, 6
    v_xor_b32 v6, s3, v6
    v_bfe_u32 v14, v1, 4, 1
    v_lshl_or_b32 v6, v14, 15, v6
    s_and_b32 s61, s60, 3
    s_lshl_b32 s61, s61, 5
    v_xor_b32 v6, s61, v6
    v_pk_add_f32 v[16:17], v[16:17], v[32:33]
    s_add_u32 s74, s70, 9568256
    buffer_load_dwordx4 v[128:131], v2, s[44:47], s74 offen offset:0 sc1
    v_pk_add_f32 v[18:19], v[18:19], v[34:35]
    v_pk_add_f32 v[20:21], v[20:21], v[36:37]
    v_pk_add_f32 v[22:23], v[22:23], v[38:39]
    v_pk_add_f32 v[24:25], v[24:25], v[40:41]
    v_pk_add_f32 v[26:27], v[26:27], v[42:43]
    v_pk_add_f32 v[28:29], v[28:29], v[44:45]
    v_pk_add_f32 v[30:31], v[30:31], v[46:47]
    s_cmp_eq_u32 s65, 0
    s_cbranch_scc1 L_44
    v_mov_b32 v32, -1
    v_mov_b32 v33, -1
    v_mov_b32 v34, -1
    v_mov_b32 v35, -1
    buffer_store_dwordx4 v[32:35], v2, s[44:47], s66 offen offset:0
    buffer_store_dwordx4 v[32:35], v2, s[44:47], s66 offen offset:1024
    s_branch L_45
L_44:
    s_nop 0
    v_mov_b32 v32, -1
    v_mov_b32 v33, -1
    v_mov_b32 v34, -1
    v_mov_b32 v35, -1
    buffer_store_dwordx4 v[32:35], v2, s[44:47], s66 offen offset:0 sc1
    buffer_store_dwordx4 v[32:35], v2, s[44:47], s66 offen offset:1024 sc1
L_45:
    v_pk_mul_f32 v[48:49], v[16:17], v[16:17]
    buffer_load_dwordx4 v[132:135], v2, s[44:47], s74 offen offset:1024 sc1
    v_pk_add_f32 v[50:51], v[16:17], v[18:19]
    v_pk_fma_f32 v[48:49], v[18:19], v[18:19], v[48:49]
    v_pk_fma_f32 v[48:49], v[20:21], v[20:21], v[48:49]
    v_pk_fma_f32 v[48:49], v[22:23], v[22:23], v[48:49]
    v_pk_fma_f32 v[48:49], v[24:25], v[24:25], v[48:49]
    v_pk_fma_f32 v[48:49], v[26:27], v[26:27], v[48:49]
    v_pk_fma_f32 v[48:49], v[28:29], v[28:29], v[48:49]
    v_pk_fma_f32 v[48:49], v[30:31], v[30:31], v[48:49]
    v_pk_add_f32 v[50:51], v[50:51], v[20:21]
    v_pk_add_f32 v[50:51], v[50:51], v[22:23]
    v_pk_add_f32 v[50:51], v[50:51], v[24:25]
    v_pk_add_f32 v[50:51], v[50:51], v[26:27]
    v_pk_add_f32 v[50:51], v[50:51], v[28:29]
    buffer_load_dwordx4 v[136:139], v2, s[44:47], s74 offen offset:2048 sc1
    v_pk_add_f32 v[50:51], v[50:51], v[30:31]
    v_add_f32 v13, v48, v49
    v_add_f32 v12, v50, v51
    s_nop 1
    v_permlane32_swap_b32 v12, v13
    v_add_f32 v12, v12, v13
    ds_write_b32 v9, v12
    s_waitcnt lgkmcnt(0)
    s_barrier
    ds_read2st64_b32 v[48:49], v10 offset0:0 offset1:1
    ds_read2st64_b32 v[50:51], v10 offset0:2 offset1:3
    ds_read2st64_b32 v[52:53], v10 offset0:4 offset1:5
    ds_read2st64_b32 v[54:55], v10 offset0:6 offset1:7
    s_waitcnt lgkmcnt(0)
    v_pk_add_f32 v[48:49], v[48:49], v[50:51]
    buffer_load_dwordx4 v[140:143], v2, s[44:47], s74 offen offset:3072 sc1
    v_pk_add_f32 v[52:53], v[52:53], v[54:55]
    v_pk_add_f32 v[48:49], v[48:49], v[52:53]
    v_add_f32 v12, v48, v49
    v_mul_f32 v12, 0x3b800000, v12
    v_mov_b32 v13, v12
    s_nop 1
    v_permlane32_swap_b32 v12, v13
    v_fma_f32 v13, -v12, v12, v13
    v_max_f32 v13, 0, v13
    v_add_f32 v13, 0x3727c5ac, v13
    v_rsq_f32 v14, v13
    s_nop 0
    v_mul_f32_e64 v15, -v12, v14
    v_pk_fma_f32 v[48:49], v[16:17], v[14:15], v[14:15] op_sel:[0,0,1] op_sel_hi:[1,0,1]
    s_add_u32 s74, s70, 9572352
    buffer_load_dwordx4 v[144:147], v2, s[44:47], s74 offen offset:0 sc1
    v_pk_fma_f32 v[50:51], v[18:19], v[14:15], v[14:15] op_sel:[0,0,1] op_sel_hi:[1,0,1]
    v_pk_fma_f32 v[52:53], v[20:21], v[14:15], v[14:15] op_sel:[0,0,1] op_sel_hi:[1,0,1]
    v_pk_fma_f32 v[54:55], v[22:23], v[14:15], v[14:15] op_sel:[0,0,1] op_sel_hi:[1,0,1]
    v_pk_fma_f32 v[56:57], v[24:25], v[14:15], v[14:15] op_sel:[0,0,1] op_sel_hi:[1,0,1]
    v_pk_fma_f32 v[58:59], v[26:27], v[14:15], v[14:15] op_sel:[0,0,1] op_sel_hi:[1,0,1]
    v_pk_fma_f32 v[60:61], v[28:29], v[14:15], v[14:15] op_sel:[0,0,1] op_sel_hi:[1,0,1]
    v_pk_fma_f32 v[62:63], v[30:31], v[14:15], v[14:15] op_sel:[0,0,1] op_sel_hi:[1,0,1]
    v_cvt_pk_bf16_f32 v48, v48, v49
    v_cvt_pk_bf16_f32 v49, v50, v51
    v_cvt_pk_bf16_f32 v50, v52, v53
    v_cvt_pk_bf16_f32 v51, v54, v55
    v_cvt_pk_bf16_f32 v52, v56, v57
    v_cvt_pk_bf16_f32 v53, v58, v59
    buffer_load_dwordx4 v[148:151], v2, s[44:47], s74 offen offset:1024 sc1
    v_cvt_pk_bf16_f32 v54, v60, v61
    v_cvt_pk_bf16_f32 v55, v62, v63
    ds_write_b128 v7, v[48:51]
    ds_write_b128 v7, v[52:55] offset:1024
    s_waitcnt vmcnt(6)
    s_waitcnt lgkmcnt(0)
    s_barrier
    v_and_b32 v12, 0x1ff, v2
    v_add_u32 v12, 149504, v12
    ds_read_b128 v[224:227], v12 offset:0
    ds_read_b128 v[228:231], v12 offset:512
    ds_read_b128 v[232:235], v12 offset:1024
    ds_read_b128 v[236:239], v12 offset:1536
    ds_read_b128 v[240:243], v12 offset:12288
    buffer_load_dwordx4 v[152:155], v2, s[44:47], s74 offen offset:2048 sc1
    ds_read_b128 v[244:247], v12 offset:12800
    ds_read_b128 v[248:251], v12 offset:13312
    ds_read_b128 v[252:255], v12 offset:13824
    v_and_b32 v15, 31, v1
    s_cmp_ge_u32 s60, 4
    s_cbranch_scc1 L_46
    ds_read_b128 v[192:195], v8 offset:0
    ds_read_b64_tr_b16 v[196:197], v6 offset:0
    ds_read_b64_tr_b16 v[198:199], v6 offset:1024
    ds_read_b128 v[200:203], v8 offset:1024
    ds_read_b64_tr_b16 v[204:205], v6 offset:2048
    ds_read_b64_tr_b16 v[206:207], v6 offset:3072
    ds_read_b128 v[208:211], v8 offset:2048
    ds_read_b64_tr_b16 v[212:213], v6 offset:4096
    ds_read_b64_tr_b16 v[214:215], v6 offset:5120
    s_waitcnt lgkmcnt(6)
    v_mfma_f32_32x32x16_bf16 v[32:47], v[196:199], v[192:195], 0
    ds_read_b128 v[216:219], v8 offset:3072
    ds_read_b64_tr_b16 v[220:221], v6 offset:6144
    ds_read_b64_tr_b16 v[222:223], v6 offset:7168
    buffer_load_dwordx4 v[156:159], v2, s[44:47], s74 offen offset:3072 sc1
    s_waitcnt lgkmcnt(6)
    v_mfma_f32_32x32x16_bf16 v[32:47], v[204:207], v[200:203], v[32:47]
    ds_read_b128 v[192:195], v8 offset:4096
    ds_read_b64_tr_b16 v[196:197], v6 offset:8192
    ds_read_b64_tr_b16 v[198:199], v6 offset:9216
    s_add_u32 s74, s70, 9576448
    buffer_load_dwordx4 v[160:163], v2, s[44:47], s74 offen offset:0 sc1
    s_waitcnt lgkmcnt(6)
    v_mfma_f32_32x32x16_bf16 v[32:47], v[212:215], v[208:211], v[32:47]
    ds_read_b128 v[200:203], v8 offset:5120
    ds_read_b64_tr_b16 v[204:205], v6 offset:10240
    ds_read_b64_tr_b16 v[206:207], v6 offset:11264
    buffer_load_dwordx4 v[164:167], v2, s[44:47], s74 offen offset:1024 sc1
    s_waitcnt lgkmcnt(6)
    v_mfma_f32_32x32x16_bf16 v[32:47], v[220:223], v[216:219], v[32:47]
    ds_read_b128 v[208:211], v8 offset:6144
    ds_read_b64_tr_b16 v[212:213], v6 offset:12288
    ds_read_b64_tr_b16 v[214:215], v6 offset:13312
    buffer_load_dwordx4 v[168:171], v2, s[44:47], s74 offen offset:2048 sc1
    s_waitcnt lgkmcnt(6)
    v_mfma_f32_32x32x16_bf16 v[32:47], v[196:199], v[192:195], v[32:47]
    ds_read_b128 v[216:219], v8 offset:7168
    ds_read_b64_tr_b16 v[220:221], v6 offset:14336
    ds_read_b64_tr_b16 v[222:223], v6 offset:15360
    buffer_load_dwordx4 v[172:175], v2, s[44:47], s74 offen offset:3072 sc1
    s_waitcnt lgkmcnt(6)
    v_mfma_f32_32x32x16_bf16 v[32:47], v[204:207], v[200:203], v[32:47]
    ds_read_b128 v[192:195], v8 offset:8192
    ds_read_b64_tr_b16 v[196:197], v6 offset:16384
    ds_read_b64_tr_b16 v[198:199], v6 offset:17408
    s_add_u32 s74, s70, 9580544
    buffer_load_dwordx4 v[176:179], v2, s[44:47], s74 offen offset:0 sc1
    s_waitcnt lgkmcnt(6)
    v_mfma_f32_32x32x16_bf16 v[32:47], v[212:215], v[208:211], v[32:47]
    ds_read_b128 v[200:203], v8 offset:9216
    ds_read_b64_tr_b16 v[204:205], v6 offset:18432
    ds_read_b64_tr_b16 v[206:207], v6 offset:19456
    buffer_load_dwordx4 v[180:183], v2, s[44:47], s74 offen offset:1024 sc1
    s_waitcnt lgkmcnt(6)
    v_mfma_f32_32x32x16_bf16 v[32:47], v[220:223], v[216:219], v[32:47]
    ds_read_b128 v[208:211], v8 offset:10240
    ds_read_b64_tr_b16 v[212:213], v6 offset:20480
    ds_read_b64_tr_b16 v[214:215], v6 offset:21504
    buffer_load_dwordx4 v[184:187], v2, s[44:47], s74 offen offset:2048 sc1
    s_waitcnt lgkmcnt(6)
    v_mfma_f32_32x32x16_bf16 v[32:47], v[196:199], v[192:195], v[32:47]
    ds_read_b128 v[216:219], v8 offset:11264
    ds_read_b64_tr_b16 v[220:221], v6 offset:22528
    ds_read_b64_tr_b16 v[222:223], v6 offset:23552
    buffer_load_dwordx4 v[188:191], v2, s[44:47], s74 offen offset:3072 sc1
    s_waitcnt lgkmcnt(6)
    v_mfma_f32_32x32x16_bf16 v[32:47], v[204:207], v[200:203], v[32:47]
    ds_read_b128 v[192:195], v8 offset:12288
    ds_read_b64_tr_b16 v[196:197], v6 offset:24576
    ds_read_b64_tr_b16 v[198:199], v6 offset:25600
    s_add_u32 m0, s72, 65536
    s_add_u32 s75, s34, 0
    buffer_load_dwordx4 v5, s[36:39], s75 offen lds
    s_waitcnt lgkmcnt(6)
    v_mfma_f32_32x32x16_bf16 v[32:47], v[212:215], v[208:211], v[32:47]
    ds_read_b128 v[200:203], v8 offset:13312
    ds_read_b64_tr_b16 v[204:205], v6 offset:26624
    ds_read_b64_tr_b16 v[206:207], v6 offset:27648
    s_add_u32 m0, s72, 66560
    s_add_u32 s75, s34, 16384
    buffer_load_dwordx4 v5, s[36:39], s75 offen lds
    s_waitcnt lgkmcnt(6)
    v_mfma_f32_32x32x16_bf16 v[32:47], v[220:223], v[216:219], v[32:47]
    ds_read_b128 v[208:211], v8 offset:14336
    ds_read_b64_tr_b16 v[212:213], v6 offset:28672
    ds_read_b64_tr_b16 v[214:215], v6 offset:29696
    s_add_u32 m0, s72, 67584
    s_add_u32 s75, s34, 32768
    buffer_load_dwordx4 v5, s[36:39], s75 offen lds
    s_waitcnt lgkmcnt(6)
    v_mfma_f32_32x32x16_bf16 v[32:47], v[196:199], v[192:195], v[32:47]
    ds_read_b128 v[216:219], v8 offset:15360
    ds_read_b64_tr_b16 v[220:221], v6 offset:30720
    ds_read_b64_tr_b16 v[222:223], v6 offset:31744
    s_waitcnt lgkmcnt(6)
    v_mfma_f32_32x32x16_bf16 v[32:47], v[204:207], v[200:203], v[32:47]
    s_waitcnt lgkmcnt(3)
    v_mfma_f32_32x32x16_bf16 v[32:47], v[212:215], v[208:211], v[32:47]
    s_waitcnt lgkmcnt(0)
    v_mfma_f32_32x32x16_bf16 v[32:47], v[220:223], v[216:219], v[32:47]
    s_mov_b32 s6, 0xbfb8aa3b
    s_mov_b32 s7, 0xbfb8aa3b
    s_nop 9
    v_pk_mul_f32 v[48:49], v[40:41], s[6:7]
    v_pk_mul_f32 v[50:51], v[42:43], s[6:7]
    v_pk_mul_f32 v[52:53], v[44:45], s[6:7]
    v_pk_mul_f32 v[54:55], v[46:47], s[6:7]
    v_exp_f32 v48, v48
    v_exp_f32 v49, v49
    v_exp_f32 v50, v50
    v_exp_f32 v51, v51
    v_exp_f32 v52, v52
    v_exp_f32 v53, v53
    v_exp_f32 v54, v54
    v_exp_f32 v55, v55
    v_pk_add_f32 v[48:49], v[48:49], 1.0 op_sel_hi:[1,0]
    v_pk_add_f32 v[50:51], v[50:51], 1.0 op_sel_hi:[1,0]
    v_pk_add_f32 v[52:53], v[52:53], 1.0 op_sel_hi:[1,0]
    v_pk_add_f32 v[54:55], v[54:55], 1.0 op_sel_hi:[1,0]
    v_rcp_f32 v48, v48
    v_rcp_f32 v49, v49
    v_rcp_f32 v50, v50
    v_rcp_f32 v51, v51
    v_rcp_f32 v52, v52
    v_rcp_f32 v53, v53
    v_rcp_f32 v54, v54
    v_rcp_f32 v55, v55
    s_lshl_b32 s61, s59, 5
    v_add_u32 v12, s61, v15
    v_cmp_gt_u32 vcc, 1000, v12
    v_pk_mul_f32 v[48:49], v[32:33], v[48:49]
    v_pk_mul_f32 v[50:51], v[34:35], v[50:51]
    v_pk_mul_f32 v[52:53], v[36:37], v[52:53]
    v_pk_mul_f32 v[54:55], v[38:39], v[54:55]
    v_cvt_pk_bf16_f32 v48, v48, v49
    v_cvt_pk_bf16_f32 v49, v50, v51
    v_cvt_pk_bf16_f32 v50, v52, v53
    v_cvt_pk_bf16_f32 v51, v54, v55
    v_cndmask_b32 v48, 0, v48, vcc
    v_cndmask_b32 v49, 0, v49, vcc
    v_cndmask_b32 v50, 0, v50, vcc
    v_cndmask_b32 v51, 0, v51, vcc
    s_add_u32 s61, s67, 7340032
    buffer_store_dwordx4 v[48:51], v2, s[44:47], s61 offen sc1
    v_add_u32 v15, 16, v15
    s_branch L_47
L_46:
    buffer_load_dwordx4 v[156:159], v2, s[44:47], s74 offen offset:3072 sc1
    s_add_u32 s74, s70, 9576448
    buffer_load_dwordx4 v[160:163], v2, s[44:47], s74 offen offset:0 sc1
    buffer_load_dwordx4 v[164:167], v2, s[44:47], s74 offen offset:1024 sc1
    buffer_load_dwordx4 v[168:171], v2, s[44:47], s74 offen offset:2048 sc1
    buffer_load_dwordx4 v[172:175], v2, s[44:47], s74 offen offset:3072 sc1
    s_add_u32 s74, s70, 9580544
    buffer_load_dwordx4 v[176:179], v2, s[44:47], s74 offen offset:0 sc1
    buffer_load_dwordx4 v[180:183], v2, s[44:47], s74 offen offset:1024 sc1
    buffer_load_dwordx4 v[184:187], v2, s[44:47], s74 offen offset:2048 sc1
    buffer_load_dwordx4 v[188:191], v2, s[44:47], s74 offen offset:3072 sc1
    s_add_u32 m0, s72, 65536
    s_add_u32 s75, s34, 0
    buffer_load_dwordx4 v5, s[36:39], s75 offen lds
    s_add_u32 m0, s72, 66560
    s_add_u32 s75, s34, 16384
    buffer_load_dwordx4 v5, s[36:39], s75 offen lds
    s_add_u32 m0, s72, 67584
    s_add_u32 s75, s34, 32768
    buffer_load_dwordx4 v5, s[36:39], s75 offen lds
    s_add_u32 s62, s67, 7319552
    v_xor_b32 v13, 0x100, v2
    v_bfe_u32 v14, v1, 4, 1
    v_lshl_or_b32 v13, v14, 15, v13
    v_lshl_add_u32 v15, v14, 5, v15
    v_mul_u32_u24 v14, 31, v14
    v_cmp_eq_u32 vcc, s59, v14
    v_mov_b32 v14, 0x7ffffff0
    s_nop 0
    v_cndmask_b32 v13, v13, v14, vcc
    s_movk_i32 s4, 0x4000
    s_nop 1
P_48:
    buffer_load_dwordx4 v[48:51], v13, s[44:47], s62 offen sc1
    s_waitcnt vmcnt(0)
    v_max_u32 v12, v48, v49
    v_max3_u32 v12, v12, v50, v51
    v_cmp_eq_u32 vcc, -1, v12
    s_nop 1
    s_cbranch_vccz D_49
    s_sleep 1
    s_sub_u32 s4, s4, 1
    s_cbranch_scc0 P_48
D_49:
    s_nop 1
L_47:
    v_mul_u32_u24 v15, 144, v15
    s_add_u32 m0, s72, 68608
    s_add_u32 s75, s34, 49152
    buffer_load_dwordx4 v5, s[36:39], s75 offen lds
    v_lshrrev_b32 v12, 5, v1
    v_lshl_add_u32 v15, v12, 4, v15
    s_and_b32 s61, s60, 3
    s_lshl_b32 s61, s61, 5
    s_add_u32 s61, s61, 151552
    v_add_u32 v15, s61, v15
    ds_write_b128 v15, v[48:51]
    v_mul_u32_u24 v12, 144, v12
    v_and_b32 v13, 31, v1
    v_lshl_add_u32 v12, v13, 2, v12
    s_mul_i32 s61, s60, 576
    s_add_u32 s61, s61, 151696
    s_add_u32 s62, s61, 0
    v_add_u32 v40, s62, v12
    s_add_u32 s62, s61, 1152
    v_add_u32 v41, s62, v12
    s_add_u32 m0, s72, 69632
    s_add_u32 s75, s34, 65536
    buffer_load_dwordx4 v5, s[36:39], s75 offen lds
    s_add_u32 s62, s61, 2304
    v_add_u32 v42, s62, v12
    s_add_u32 s62, s61, 3456
    v_add_u32 v43, s62, v12
    s_add_u32 s62, s61, 4608
    v_add_u32 v44, s62, v12
    v_mov_b32 v32, 0
    v_mov_b32 v33, 0
    v_mov_b32 v34, 0
    v_mov_b32 v35, 0
    s_mov_b32 s63, 0x05040100
    s_mov_b32 s3, 0x07060302
    s_waitcnt vmcnt(0)
    s_waitcnt lgkmcnt(0)
    s_barrier
    ds_read2_b32 v[192:193], v40 offset0:0 offset1:36
    ds_read2_b32 v[194:195], v40 offset0:72 offset1:108
    s_add_u32 m0, s72, 70656
    s_add_u32 s75, s34, 81920
    buffer_load_dwordx4 v5, s[36:39], s75 offen lds
    ds_read2_b32 v[196:197], v40 offset0:144 offset1:180
    ds_read2_b32 v[198:199], v40 offset0:216 offset1:252
    ds_read2_b32 v[200:201], v41 offset0:0 offset1:36
    ds_read2_b32 v[202:203], v41 offset0:72 offset1:108
    ds_read2_b32 v[204:205], v41 offset0:144 offset1:180
    ds_read2_b32 v[206:207], v41 offset0:216 offset1:252
    ds_read2_b32 v[208:209], v42 offset0:0 offset1:36
    ds_read2_b32 v[210:211], v42 offset0:72 offset1:108
    ds_read2_b32 v[212:213], v42 offset0:144 offset1:180
    ds_read2_b32 v[214:215], v42 offset0:216 offset1:252
    ds_read2_b32 v[216:217], v43 offset0:0 offset1:36
    ds_read2_b32 v[218:219], v43 offset0:72 offset1:108
    ds_read2_b32 v[220:221], v43 offset0:144 offset1:180
    s_add_u32 m0, s72, 71680
    s_add_u32 s75, s34, 98304
    buffer_load_dwordx4 v5, s[36:39], s75 offen lds
    ds_read2_b32 v[222:223], v43 offset0:216 offset1:252
    ds_read2_b32 v[36:37], v44 offset0:0 offset1:36
    s_waitcnt lgkmcnt(15)
    v_perm_b32 v48, v193, v192, s63
    v_perm_b32 v193, v193, v192, s3
    s_waitcnt lgkmcnt(15)
    v_perm_b32 v49, v195, v194, s63
    v_perm_b32 v195, v195, v194, s3
    s_waitcnt lgkmcnt(14)
    v_perm_b32 v50, v197, v196, s63
    v_perm_b32 v197, v197, v196, s3
    s_waitcnt lgkmcnt(13)
    v_perm_b32 v51, v199, v198, s63
    v_perm_b32 v199, v199, v198, s3
    s_waitcnt lgkmcnt(12)
    v_perm_b32 v52, v201, v200, s63
    s_add_u32 m0, s72, 72704
    s_add_u32 s75, s34, 114688
    buffer_load_dwordx4 v5, s[36:39], s75 offen lds
    v_perm_b32 v201, v201, v200, s3
    s_waitcnt lgkmcnt(11)
    v_perm_b32 v53, v203, v202, s63
    v_perm_b32 v203, v203, v202, s3
    s_waitcnt lgkmcnt(10)
    v_perm_b32 v54, v205, v204, s63
    v_perm_b32 v205, v205, v204, s3
    s_waitcnt lgkmcnt(9)
    v_perm_b32 v55, v207, v206, s63
    v_perm_b32 v207, v207, v206, s3
    s_waitcnt lgkmcnt(8)
    v_perm_b32 v56, v209, v208, s63
    v_perm_b32 v209, v209, v208, s3
    s_waitcnt lgkmcnt(7)
    v_perm_b32 v57, v211, v210, s63
    s_add_u32 m0, s72, 0
    s_add_u32 s75, s34, 262144
    buffer_load_dwordx4 v5, s[36:39], s75 offen lds
    v_perm_b32 v211, v211, v210, s3
    s_waitcnt lgkmcnt(6)
    v_perm_b32 v58, v213, v212, s63
    v_perm_b32 v213, v213, v212, s3
    s_waitcnt lgkmcnt(5)
    v_perm_b32 v59, v215, v214, s63
    v_perm_b32 v215, v215, v214, s3
    s_waitcnt lgkmcnt(4)
    v_perm_b32 v60, v217, v216, s63
    v_perm_b32 v217, v217, v216, s3
    s_waitcnt lgkmcnt(3)
    v_perm_b32 v61, v219, v218, s63
    v_perm_b32 v219, v219, v218, s3
    s_waitcnt lgkmcnt(2)
    v_perm_b32 v62, v221, v220, s63
    s_add_u32 m0, s72, 1024
    s_add_u32 s75, s34, 278528
    buffer_load_dwordx4 v5, s[36:39], s75 offen lds
    v_perm_b32 v221, v221, v220, s3
    s_waitcnt lgkmcnt(1)
    v_perm_b32 v63, v223, v222, s63
    v_perm_b32 v223, v223, v222, s3
    s_waitcnt lgkmcnt(0)
    v_perm_b32 v38, v37, v36, s63
    v_perm_b32 v37, v37, v36, s3
    v_dot2c_f32_bf16 v32, v48, v224
    v_dot2c_f32_bf16 v33, v193, v240
    v_dot2c_f32_bf16 v34, v49, v224
    v_dot2c_f32_bf16 v35, v195, v240
    v_dot2c_f32_bf16 v32, v49, v225
    v_dot2c_f32_bf16 v33, v195, v241
    v_dot2c_f32_bf16 v34, v50, v225
    s_add_u32 m0, s72, 2048
    s_add_u32 s75, s34, 294912
    buffer_load_dwordx4 v5, s[36:39], s75 offen lds
    v_dot2c_f32_bf16 v35, v197, v241
    v_dot2c_f32_bf16 v32, v50, v226
    v_dot2c_f32_bf16 v33, v197, v242
    v_dot2c_f32_bf16 v34, v51, v226
    v_dot2c_f32_bf16 v35, v199, v242
    v_dot2c_f32_bf16 v32, v51, v227
    v_dot2c_f32_bf16 v33, v199, v243
    v_dot2c_f32_bf16 v34, v52, v227
    v_dot2c_f32_bf16 v35, v201, v243
    v_dot2c_f32_bf16 v32, v52, v228
    v_dot2c_f32_bf16 v33, v201, v244
    v_dot2c_f32_bf16 v34, v53, v228
    v_dot2c_f32_bf16 v35, v203, v244
    s_add_u32 m0, s72, 3072
    s_add_u32 s75, s34, 311296
    buffer_load_dwordx4 v5, s[36:39], s75 offen lds
    v_dot2c_f32_bf16 v32, v53, v229
    v_dot2c_f32_bf16 v33, v203, v245
    v_dot2c_f32_bf16 v34, v54, v229
    v_dot2c_f32_bf16 v35, v205, v245
    v_dot2c_f32_bf16 v32, v54, v230
    v_dot2c_f32_bf16 v33, v205, v246
    v_dot2c_f32_bf16 v34, v55, v230
    v_dot2c_f32_bf16 v35, v207, v246
    v_dot2c_f32_bf16 v32, v55, v231
    v_dot2c_f32_bf16 v33, v207, v247
    v_dot2c_f32_bf16 v34, v56, v231
    v_dot2c_f32_bf16 v35, v209, v247
    v_dot2c_f32_bf16 v32, v56, v232
    s_add_u32 m0, s72, 4096
    s_add_u32 s75, s34, 327680
    buffer_load_dwordx4 v5, s[36:39], s75 offen lds
    v_dot2c_f32_bf16 v33, v209, v248
    v_dot2c_f32_bf16 v34, v57, v232
    v_dot2c_f32_bf16 v35, v211, v248
    v_dot2c_f32_bf16 v32, v57, v233
    v_dot2c_f32_bf16 v33, v211, v249
    v_dot2c_f32_bf16 v34, v58, v233
    v_dot2c_f32_bf16 v35, v213, v249
    v_dot2c_f32_bf16 v32, v58, v234
    v_dot2c_f32_bf16 v33, v213, v250
    v_dot2c_f32_bf16 v34, v59, v234
    v_dot2c_f32_bf16 v35, v215, v250
    v_dot2c_f32_bf16 v32, v59, v235
    v_dot2c_f32_bf16 v33, v215, v251
    s_add_u32 m0, s72, 5120
    s_add_u32 s75, s34, 344064
    buffer_load_dwordx4 v5, s[36:39], s75 offen lds
    v_dot2c_f32_bf16 v34, v60, v235
    v_dot2c_f32_bf16 v35, v217, v251
    v_dot2c_f32_bf16 v32, v60, v236
    v_dot2c_f32_bf16 v33, v217, v252
    v_dot2c_f32_bf16 v34, v61, v236
    v_dot2c_f32_bf16 v35, v219, v252
    v_dot2c_f32_bf16 v32, v61, v237
    v_dot2c_f32_bf16 v33, v219, v253
    v_dot2c_f32_bf16 v34, v62, v237
    v_dot2c_f32_bf16 v35, v221, v253
    v_dot2c_f32_bf16 v32, v62, v238
    v_dot2c_f32_bf16 v33, v221, v254
    v_dot2c_f32_bf16 v34, v63, v238
    s_add_u32 m0, s72, 6144
    s_add_u32 s75, s34, 360448
    buffer_load_dwordx4 v5, s[36:39], s75 offen lds
    v_dot2c_f32_bf16 v35, v223, v254
    v_dot2c_f32_bf16 v32, v63, v239
    v_dot2c_f32_bf16 v33, v223, v255
    v_dot2c_f32_bf16 v34, v38, v239
    v_dot2c_f32_bf16 v35, v37, v255
    s_mov_b32 s6, 0xbfb8aa3b
    s_mov_b32 s7, 0xbfb8aa3b
    v_pk_mul_f32 v[48:49], v[32:33], s[6:7]
    v_pk_mul_f32 v[50:51], v[34:35], s[6:7]
    v_exp_f32 v48, v48
    v_exp_f32 v49, v49
    v_exp_f32 v50, v50
    s_add_u32 m0, s72, 7168
    s_add_u32 s75, s34, 376832
    buffer_load_dwordx4 v5, s[36:39], s75 offen lds
    v_exp_f32 v51, v51
    v_pk_add_f32 v[48:49], v[48:49], 1.0 op_sel_hi:[1,0]
    v_pk_add_f32 v[50:51], v[50:51], 1.0 op_sel_hi:[1,0]
    v_rcp_f32 v48, v48
    v_rcp_f32 v49, v49
    v_rcp_f32 v50, v50
    v_rcp_f32 v51, v51
    v_pk_mul_f32 v[32:33], v[32:33], v[48:49]
    s_add_u32 s74, s71, 9699328
    buffer_load_dwordx4 v[64:67], v2, s[44:47], s74 offen offset:0 sc1
    v_pk_mul_f32 v[34:35], v[34:35], v[50:51]
    v_cvt_pk_bf16_f32 v48, v32, v33
    v_cvt_pk_bf16_f32 v49, v34, v35
    v_bfe_u32 v12, v1, 2, 3
    v_lshlrev_b32 v12, 9, v12
    v_lshrrev_b32 v13, 5, v1
    v_lshl_or_b32 v12, v13, 4, v12
    v_and_b32 v13, 3, v1
    v_lshl_or_b32 v12, v13, 2, v12
    s_lshl_b32 s61, s5, 12
    s_lshl_b32 s62, s60, 6
    s_add_u32 s61, s61, s62
    s_add_u32 s61, s61, 8388608
    s_cmp_eq_u32 s65, 0
    s_cbranch_scc1 L_50
    buffer_store_dword v48, v12, s[44:47], s61 offen
    buffer_store_dword v49, v12, s[44:47], s61 offen offset:32
    s_branch L_51
L_50:
    buffer_store_dword v48, v12, s[44:47], s61 offen sc1
    buffer_store_dword v49, v12, s[44:47], s61 offen offset:32 sc1
L_51:
    s_lshl_b32 s61, s57, 14
    s_lshl_b32 s62, s60, 11
    s_add_u32 s61, s61, s62
    s_add_u32 s61, s61, 8388608
    s_sleep 5
    s_movk_i32 s4, 0x4000
    s_nop 1
P_52:
    buffer_load_dwordx4 v[48:51], v2, s[44:47], s61 offen offset:0 sc1
    buffer_load_dwordx4 v[52:55], v2, s[44:47], s61 offen offset:1024 sc1
    s_waitcnt vmcnt(0)
    v_max_u32 v12, v48, v49
    v_max3_u32 v12, v12, v50, v51
    v_max3_u32 v12, v12, v52, v53
    v_max3_u32 v12, v12, v54, v55
    v_cmp_eq_u32 vcc, -1, v12
    s_nop 1
    s_cbranch_vccz D_53
    s_sleep 1
    s_sub_u32 s4, s4, 1
    s_cbranch_scc0 P_52
D_53:
    s_nop 1
    ds_write_b128 v7, v[48:51]
    buffer_load_dwordx4 v[68:71], v2, s[44:47], s74 offen offset:1024 sc1
    ds_write_b128 v7, v[52:55] offset:1024
    s_waitcnt lgkmcnt(0)
    s_barrier
    ds_read_b128 v[192:195], v8 offset:0
    ds_read_b128 v[196:199], v8 offset:1024
    ds_read_b128 v[200:203], v8 offset:2048
    ds_read_b128 v[204:207], v8 offset:3072
    ds_read_b128 v[208:211], v8 offset:4096
    ds_read_b128 v[212:215], v8 offset:5120
    ds_read_b128 v[216:219], v8 offset:6144
    s_waitcnt lgkmcnt(6)
    v_mfma_f32_32x32x16_bf16 v[32:47], v[128:131], v[192:195], 0
    buffer_load_dwordx4 v[72:75], v2, s[44:47], s74 offen offset:2048 sc1
    ds_read_b128 v[220:223], v8 offset:7168
    s_waitcnt lgkmcnt(6)
    v_mfma_f32_32x32x16_bf16 v[32:47], v[132:135], v[196:199], v[32:47]
    ds_read_b128 v[192:195], v8 offset:8192
    s_waitcnt lgkmcnt(6)
    v_mfma_f32_32x32x16_bf16 v[32:47], v[136:139], v[200:203], v[32:47]
    buffer_load_dwordx4 v[76:79], v2, s[44:47], s74 offen offset:3072 sc1
    ds_read_b128 v[196:199], v8 offset:9216
    s_waitcnt lgkmcnt(6)
    v_mfma_f32_32x32x16_bf16 v[32:47], v[140:143], v[204:207], v[32:47]
    ds_read_b128 v[200:203], v8 offset:10240
    s_waitcnt lgkmcnt(6)
    v_mfma_f32_32x32x16_bf16 v[32:47], v[144:147], v[208:211], v[32:47]
    s_add_u32 s74, s71, 9703424
    buffer_load_dwordx4 v[80:83], v2, s[44:47], s74 offen offset:0 sc1
    ds_read_b128 v[204:207], v8 offset:11264
    s_waitcnt lgkmcnt(6)
    v_mfma_f32_32x32x16_bf16 v[32:47], v[148:151], v[212:215], v[32:47]
    ds_read_b128 v[208:211], v8 offset:12288
    s_waitcnt lgkmcnt(6)
    v_mfma_f32_32x32x16_bf16 v[32:47], v[152:155], v[216:219], v[32:47]
    buffer_load_dwordx4 v[84:87], v2, s[44:47], s74 offen offset:1024 sc1
    ds_read_b128 v[212:215], v8 offset:13312
    s_waitcnt lgkmcnt(6)
    v_mfma_f32_32x32x16_bf16 v[32:47], v[156:159], v[220:223], v[32:47]
    ds_read_b128 v[216:219], v8 offset:14336
    s_waitcnt lgkmcnt(6)
    v_mfma_f32_32x32x16_bf16 v[32:47], v[160:163], v[192:195], v[32:47]
    buffer_load_dwordx4 v[88:91], v2, s[44:47], s74 offen offset:2048 sc1
    ds_read_b128 v[220:223], v8 offset:15360
    s_waitcnt lgkmcnt(6)
    v_mfma_f32_32x32x16_bf16 v[32:47], v[164:167], v[196:199], v[32:47]
    s_waitcnt lgkmcnt(5)
    v_mfma_f32_32x32x16_bf16 v[32:47], v[168:171], v[200:203], v[32:47]
    buffer_load_dwordx4 v[92:95], v2, s[44:47], s74 offen offset:3072 sc1
    s_waitcnt lgkmcnt(4)
    v_mfma_f32_32x32x16_bf16 v[32:47], v[172:175], v[204:207], v[32:47]
    s_waitcnt lgkmcnt(3)
    v_mfma_f32_32x32x16_bf16 v[32:47], v[176:179], v[208:211], v[32:47]
    s_add_u32 s74, s71, 9707520
    buffer_load_dwordx4 v[96:99], v2, s[44:47], s74 offen offset:0 sc1
    s_waitcnt lgkmcnt(2)
    v_mfma_f32_32x32x16_bf16 v[32:47], v[180:183], v[212:215], v[32:47]
    s_waitcnt lgkmcnt(1)
    v_mfma_f32_32x32x16_bf16 v[32:47], v[184:187], v[216:219], v[32:47]
    buffer_load_dwordx4 v[100:103], v2, s[44:47], s74 offen offset:1024 sc1
    s_waitcnt lgkmcnt(0)
    v_mfma_f32_32x32x16_bf16 v[32:47], v[188:191], v[220:223], v[32:47]
    s_nop 11
    v_pk_add_f32 v[16:17], v[16:17], v[32:33]
    v_pk_add_f32 v[18:19], v[18:19], v[34:35]
    v_pk_add_f32 v[20:21], v[20:21], v[36:37]
    v_pk_add_f32 v[22:23], v[22:23], v[38:39]
    buffer_load_dwordx4 v[104:107], v2, s[44:47], s74 offen offset:2048 sc1
    v_pk_add_f32 v[24:25], v[24:25], v[40:41]
    v_pk_add_f32 v[26:27], v[26:27], v[42:43]
    v_pk_add_f32 v[28:29], v[28:29], v[44:45]
    v_pk_add_f32 v[30:31], v[30:31], v[46:47]
    v_pk_mul_f32 v[48:49], v[16:17], v[16:17]
    v_pk_add_f32 v[50:51], v[16:17], v[18:19]
    v_pk_fma_f32 v[48:49], v[18:19], v[18:19], v[48:49]
    v_pk_fma_f32 v[48:49], v[20:21], v[20:21], v[48:49]
    v_pk_fma_f32 v[48:49], v[22:23], v[22:23], v[48:49]
    v_pk_fma_f32 v[48:49], v[24:25], v[24:25], v[48:49]
    v_pk_fma_f32 v[48:49], v[26:27], v[26:27], v[48:49]
    v_pk_fma_f32 v[48:49], v[28:29], v[28:29], v[48:49]
    v_pk_fma_f32 v[48:49], v[30:31], v[30:31], v[48:49]
    buffer_load_dwordx4 v[108:111], v2, s[44:47], s74 offen offset:3072 sc1
    v_pk_add_f32 v[50:51], v[50:51], v[20:21]
    v_pk_add_f32 v[50:51], v[50:51], v[22:23]
    v_pk_add_f32 v[50:51], v[50:51], v[24:25]
    v_pk_add_f32 v[50:51], v[50:51], v[26:27]
    v_pk_add_f32 v[50:51], v[50:51], v[28:29]
    v_pk_add_f32 v[50:51], v[50:51], v[30:31]
    v_add_f32 v13, v48, v49
    v_add_f32 v12, v50, v51
    s_nop 1
    v_permlane32_swap_b32 v12, v13
    v_add_f32 v12, v12, v13
    ds_write_b32 v9, v12
    s_waitcnt lgkmcnt(0)
    s_barrier
    ds_read2st64_b32 v[48:49], v10 offset0:0 offset1:1
    s_add_u32 s74, s71, 9711616
    buffer_load_dwordx4 v[112:115], v2, s[44:47], s74 offen offset:0 sc1
    ds_read2st64_b32 v[50:51], v10 offset0:2 offset1:3
    ds_read2st64_b32 v[52:53], v10 offset0:4 offset1:5
    ds_read2st64_b32 v[54:55], v10 offset0:6 offset1:7
    s_waitcnt lgkmcnt(0)
    v_pk_add_f32 v[48:49], v[48:49], v[50:51]
    v_pk_add_f32 v[52:53], v[52:53], v[54:55]
    v_pk_add_f32 v[48:49], v[48:49], v[52:53]
    v_add_f32 v12, v48, v49
    v_mul_f32 v12, 0x3b800000, v12
    v_mov_b32 v13, v12
    s_nop 1
    v_permlane32_swap_b32 v12, v13
    v_fma_f32 v13, -v12, v12, v13
    v_max_f32 v13, 0, v13
    buffer_load_dwordx4 v[116:119], v2, s[44:47], s74 offen offset:1024 sc1
    v_add_f32 v13, 0x3727c5ac, v13
    v_rsq_f32 v14, v13
    s_nop 0
    v_mul_f32_e64 v15, -v12, v14
    v_pk_fma_f32 v[48:49], v[16:17], v[14:15], v[14:15] op_sel:[0,0,1] op_sel_hi:[1,0,1]
    v_pk_fma_f32 v[50:51], v[18:19], v[14:15], v[14:15] op_sel:[0,0,1] op_sel_hi:[1,0,1]
    v_pk_fma_f32 v[52:53], v[20:21], v[14:15], v[14:15] op_sel:[0,0,1] op_sel_hi:[1,0,1]
    v_pk_fma_f32 v[54:55], v[22:23], v[14:15], v[14:15] op_sel:[0,0,1] op_sel_hi:[1,0,1]
    v_pk_fma_f32 v[56:57], v[24:25], v[14:15], v[14:15] op_sel:[0,0,1] op_sel_hi:[1,0,1]
    v_pk_fma_f32 v[58:59], v[26:27], v[14:15], v[14:15] op_sel:[0,0,1] op_sel_hi:[1,0,1]
    v_pk_fma_f32 v[60:61], v[28:29], v[14:15], v[14:15] op_sel:[0,0,1] op_sel_hi:[1,0,1]
    v_pk_fma_f32 v[62:63], v[30:31], v[14:15], v[14:15] op_sel:[0,0,1] op_sel_hi:[1,0,1]
    v_cvt_pk_bf16_f32 v48, v48, v49
    buffer_load_dwordx4 v[120:123], v2, s[44:47], s74 offen offset:2048 sc1
    v_cvt_pk_bf16_f32 v49, v50, v51
    v_cvt_pk_bf16_f32 v50, v52, v53
    v_cvt_pk_bf16_f32 v51, v54, v55
    v_cvt_pk_bf16_f32 v52, v56, v57
    v_cvt_pk_bf16_f32 v53, v58, v59
    v_cvt_pk_bf16_f32 v54, v60, v61
    v_cvt_pk_bf16_f32 v55, v62, v63
    ds_write_b128 v7, v[48:51]
    ds_write_b128 v7, v[52:55] offset:1024
    s_waitcnt lgkmcnt(0)
    s_barrier
    ds_read_b128 v[192:195], v8 offset:0
    ds_read_b64_tr_b16 v[196:197], v4 offset:0
    ds_read_b64_tr_b16 v[198:199], v4 offset:1024
    buffer_load_dwordx4 v[124:127], v2, s[44:47], s74 offen offset:3072 sc1
    ds_read_b128 v[200:203], v8 offset:1024
    ds_read_b64_tr_b16 v[204:205], v4 offset:2048
    ds_read_b64_tr_b16 v[206:207], v4 offset:3072
    ds_read_b128 v[208:211], v8 offset:2048
    ds_read_b64_tr_b16 v[212:213], v4 offset:4096
    ds_read_b64_tr_b16 v[214:215], v4 offset:5120
    ds_read_b128 v[216:219], v8 offset:3072
    ds_read_b64_tr_b16 v[220:221], v4 offset:6144
    ds_read_b64_tr_b16 v[222:223], v4 offset:7168
    ds_read_b128 v[224:227], v8 offset:4096
    ds_read_b64_tr_b16 v[228:229], v4 offset:8192
    ds_read_b64_tr_b16 v[230:231], v4 offset:9216
    s_waitcnt lgkmcnt(12)
    v_mfma_f32_32x32x16_bf16 v[32:47], v[196:199], v[192:195], 0
    ds_read_b128 v[232:235], v8 offset:5120
    ds_read_b64_tr_b16 v[236:237], v4 offset:10240
    ds_read_b64_tr_b16 v[238:239], v4 offset:11264
    s_waitcnt lgkmcnt(12)
    v_mfma_f32_32x32x16_bf16 v[32:47], v[204:207], v[200:203], v[32:47]
    ds_read_b128 v[192:195], v8 offset:6144
    ds_read_b64_tr_b16 v[196:197], v4 offset:12288
    ds_read_b64_tr_b16 v[198:199], v4 offset:13312
    s_waitcnt lgkmcnt(12)
    v_mfma_f32_32x32x16_bf16 v[32:47], v[212:215], v[208:211], v[32:47]
    ds_read_b128 v[200:203], v8 offset:7168
    ds_read_b64_tr_b16 v[204:205], v4 offset:14336
    ds_read_b64_tr_b16 v[206:207], v4 offset:15360
    s_waitcnt lgkmcnt(12)
    v_mfma_f32_32x32x16_bf16 v[32:47], v[220:223], v[216:219], v[32:47]
    s_waitcnt lgkmcnt(9)
    v_mfma_f32_32x32x16_bf16 v[32:47], v[228:231], v[224:227], v[32:47]
    s_waitcnt lgkmcnt(6)
    v_mfma_f32_32x32x16_bf16 v[32:47], v[236:239], v[232:235], v[32:47]
    s_waitcnt lgkmcnt(3)
    v_mfma_f32_32x32x16_bf16 v[32:47], v[196:199], v[192:195], v[32:47]
    s_waitcnt lgkmcnt(0)
    v_mfma_f32_32x32x16_bf16 v[32:47], v[204:207], v[200:203], v[32:47]
    ds_read_b128 v[128:131], v8 offset:8192
    ds_read_b64_tr_b16 v[132:133], v3 offset:0
    ds_read_b64_tr_b16 v[134:135], v3 offset:1024
    ds_read_b128 v[136:139], v8 offset:9216
    ds_read_b64_tr_b16 v[140:141], v3 offset:2048
    ds_read_b64_tr_b16 v[142:143], v3 offset:3072
    ds_read_b128 v[144:147], v8 offset:10240
    ds_read_b64_tr_b16 v[148:149], v3 offset:4096
    ds_read_b64_tr_b16 v[150:151], v3 offset:5120
    ds_read_b128 v[152:155], v8 offset:11264
    ds_read_b64_tr_b16 v[156:157], v3 offset:6144
    ds_read_b64_tr_b16 v[158:159], v3 offset:7168
    ds_read_b128 v[160:163], v8 offset:12288
    ds_read_b64_tr_b16 v[164:165], v3 offset:8192
    ds_read_b64_tr_b16 v[166:167], v3 offset:9216
    s_waitcnt lgkmcnt(12)
    v_mfma_f32_32x32x16_bf16 v[32:47], v[132:135], v[128:131], v[32:47]
    ds_read_b128 v[168:171], v8 offset:13312
    ds_read_b64_tr_b16 v[172:173], v3 offset:10240
    ds_read_b64_tr_b16 v[174:175], v3 offset:11264
    s_waitcnt lgkmcnt(12)
    v_mfma_f32_32x32x16_bf16 v[32:47], v[140:143], v[136:139], v[32:47]
    ds_read_b128 v[128:131], v8 offset:14336
    ds_read_b64_tr_b16 v[132:133], v3 offset:12288
    ds_read_b64_tr_b16 v[134:135], v3 offset:13312
    s_waitcnt lgkmcnt(12)
    v_mfma_f32_32x32x16_bf16 v[32:47], v[148:151], v[144:147], v[32:47]
    ds_read_b128 v[136:139], v8 offset:15360
    ds_read_b64_tr_b16 v[140:141], v3 offset:14336
    ds_read_b64_tr_b16 v[142:143], v3 offset:15360
    s_waitcnt lgkmcnt(12)
    v_mfma_f32_32x32x16_bf16 v[32:47], v[156:159], v[152:155], v[32:47]
    s_waitcnt lgkmcnt(9)
    v_mfma_f32_32x32x16_bf16 v[32:47], v[164:167], v[160:163], v[32:47]
    s_waitcnt lgkmcnt(6)
    v_mfma_f32_32x32x16_bf16 v[32:47], v[172:175], v[168:171], v[32:47]
    s_waitcnt lgkmcnt(3)
    v_mfma_f32_32x32x16_bf16 v[32:47], v[132:135], v[128:131], v[32:47]
    s_waitcnt lgkmcnt(0)
    v_mfma_f32_32x32x16_bf16 v[32:47], v[140:143], v[136:139], v[32:47]
    s_mov_b32 s6, 0xbfb8aa3b
    s_mov_b32 s7, 0xbfb8aa3b
    s_nop 9
    v_pk_mul_f32 v[48:49], v[32:33], s[6:7]
    v_pk_mul_f32 v[50:51], v[34:35], s[6:7]
    v_pk_mul_f32 v[52:53], v[36:37], s[6:7]
    v_pk_mul_f32 v[54:55], v[38:39], s[6:7]
    v_pk_mul_f32 v[56:57], v[40:41], s[6:7]
    v_pk_mul_f32 v[58:59], v[42:43], s[6:7]
    v_pk_mul_f32 v[60:61], v[44:45], s[6:7]
    v_pk_mul_f32 v[62:63], v[46:47], s[6:7]
    v_exp_f32 v48, v48
    v_exp_f32 v49, v49
    v_exp_f32 v50, v50
    v_exp_f32 v51, v51
    v_exp_f32 v52, v52
    v_exp_f32 v53, v53
    v_exp_f32 v54, v54
    v_exp_f32 v55, v55
    v_exp_f32 v56, v56
    v_exp_f32 v57, v57
    v_exp_f32 v58, v58
    v_exp_f32 v59, v59
    v_exp_f32 v60, v60
    v_exp_f32 v61, v61
    v_exp_f32 v62, v62
    v_exp_f32 v63, v63
    v_pk_add_f32 v[48:49], v[48:49], 1.0 op_sel_hi:[1,0]
    v_pk_add_f32 v[50:51], v[50:51], 1.0 op_sel_hi:[1,0]
    v_pk_add_f32 v[52:53], v[52:53], 1.0 op_sel_hi:[1,0]
    v_pk_add_f32 v[54:55], v[54:55], 1.0 op_sel_hi:[1,0]
    v_pk_add_f32 v[56:57], v[56:57], 1.0 op_sel_hi:[1,0]
    v_pk_add_f32 v[58:59], v[58:59], 1.0 op_sel_hi:[1,0]
    v_pk_add_f32 v[60:61], v[60:61], 1.0 op_sel_hi:[1,0]
    v_pk_add_f32 v[62:63], v[62:63], 1.0 op_sel_hi:[1,0]
    v_rcp_f32 v48, v48
    v_rcp_f32 v49, v49
    v_rcp_f32 v50, v50
    v_rcp_f32 v51, v51
    v_rcp_f32 v52, v52
    v_rcp_f32 v53, v53
    v_rcp_f32 v54, v54
    v_rcp_f32 v55, v55
    v_rcp_f32 v56, v56
    v_rcp_f32 v57, v57
    v_rcp_f32 v58, v58
    v_rcp_f32 v59, v59
    v_rcp_f32 v60, v60
    v_rcp_f32 v61, v61
    v_rcp_f32 v62, v62
    v_rcp_f32 v63, v63
    v_pk_mul_f32 v[32:33], v[32:33], v[48:49]
    v_pk_mul_f32 v[34:35], v[34:35], v[50:51]
    v_pk_mul_f32 v[36:37], v[36:37], v[52:53]
    v_pk_mul_f32 v[38:39], v[38:39], v[54:55]
    v_pk_mul_f32 v[40:41], v[40:41], v[56:57]
    v_pk_mul_f32 v[42:43], v[42:43], v[58:59]
    v_pk_mul_f32 v[44:45], v[44:45], v[60:61]
    v_pk_mul_f32 v[46:47], v[46:47], v[62:63]
    v_cvt_pk_bf16_f32 v48, v32, v33
    v_cvt_pk_bf16_f32 v49, v34, v35
    v_cvt_pk_bf16_f32 v50, v36, v37
    v_cvt_pk_bf16_f32 v51, v38, v39
    v_cvt_pk_bf16_f32 v52, v40, v41
    v_cvt_pk_bf16_f32 v53, v42, v43
    v_cvt_pk_bf16_f32 v54, v44, v45
    v_cvt_pk_bf16_f32 v55, v46, v47
    ds_write_b128 v7, v[48:51] offset:16384
    ds_write_b128 v7, v[52:55] offset:17408
    s_waitcnt lgkmcnt(0)
    s_barrier
    ds_read_b128 v[192:195], v8 offset:16384
    ds_read_b128 v[196:199], v8 offset:17408
    ds_read_b128 v[200:203], v8 offset:18432
    ds_read_b128 v[204:207], v8 offset:19456
    ds_read_b128 v[208:211], v8 offset:20480
    ds_read_b128 v[212:215], v8 offset:21504
    ds_read_b128 v[216:219], v8 offset:22528
    s_waitcnt vmcnt(0)
    s_waitcnt lgkmcnt(6)
    v_mfma_f32_32x32x16_bf16 v[32:47], v[64:67], v[192:195], 0
    ds_read_b128 v[220:223], v8 offset:23552
    s_waitcnt lgkmcnt(6)
    v_mfma_f32_32x32x16_bf16 v[32:47], v[68:71], v[196:199], v[32:47]
    ds_read_b128 v[192:195], v8 offset:24576
    s_waitcnt lgkmcnt(6)
    v_mfma_f32_32x32x16_bf16 v[32:47], v[72:75], v[200:203], v[32:47]
    ds_read_b128 v[196:199], v8 offset:25600
    s_waitcnt lgkmcnt(6)
    v_mfma_f32_32x32x16_bf16 v[32:47], v[76:79], v[204:207], v[32:47]
    ds_read_b128 v[200:203], v8 offset:26624
    s_waitcnt lgkmcnt(6)
    v_mfma_f32_32x32x16_bf16 v[32:47], v[80:83], v[208:211], v[32:47]
    ds_read_b128 v[204:207], v8 offset:27648
    s_waitcnt lgkmcnt(6)
    v_mfma_f32_32x32x16_bf16 v[32:47], v[84:87], v[212:215], v[32:47]
    ds_read_b128 v[208:211], v8 offset:28672
    s_waitcnt lgkmcnt(6)
    v_mfma_f32_32x32x16_bf16 v[32:47], v[88:91], v[216:219], v[32:47]
    ds_read_b128 v[212:215], v8 offset:29696
    s_waitcnt lgkmcnt(6)
    v_mfma_f32_32x32x16_bf16 v[32:47], v[92:95], v[220:223], v[32:47]
    ds_read_b128 v[216:219], v8 offset:30720
    s_waitcnt lgkmcnt(6)
    v_mfma_f32_32x32x16_bf16 v[32:47], v[96:99], v[192:195], v[32:47]
    ds_read_b128 v[220:223], v8 offset:31744
    s_waitcnt lgkmcnt(6)
    v_mfma_f32_32x32x16_bf16 v[32:47], v[100:103], v[196:199], v[32:47]
    s_waitcnt lgkmcnt(5)
    v_mfma_f32_32x32x16_bf16 v[32:47], v[104:107], v[200:203], v[32:47]
    s_waitcnt lgkmcnt(4)
    v_mfma_f32_32x32x16_bf16 v[32:47], v[108:111], v[204:207], v[32:47]
    s_waitcnt lgkmcnt(3)
    v_mfma_f32_32x32x16_bf16 v[32:47], v[112:115], v[208:211], v[32:47]
    s_waitcnt lgkmcnt(2)
    v_mfma_f32_32x32x16_bf16 v[32:47], v[116:119], v[212:215], v[32:47]
    s_waitcnt lgkmcnt(1)
    v_mfma_f32_32x32x16_bf16 v[32:47], v[120:123], v[216:219], v[32:47]
    s_waitcnt lgkmcnt(0)
    v_mfma_f32_32x32x16_bf16 v[32:47], v[124:127], v[220:223], v[32:47]
    s_nop 11
    v_cvt_pk_bf16_f32 v48, v32, v33
    v_cvt_pk_bf16_f32 v49, v34, v35
    v_cvt_pk_bf16_f32 v50, v36, v37
    v_cvt_pk_bf16_f32 v51, v38, v39
    v_cvt_pk_bf16_f32 v52, v40, v41
    v_cvt_pk_bf16_f32 v53, v42, v43
    v_cvt_pk_bf16_f32 v54, v44, v45
    v_cvt_pk_bf16_f32 v55, v46, v47
    s_cmp_eq_u32 s65, 0
    s_cbranch_scc1 L_54
    buffer_store_dwordx4 v[48:51], v2, s[44:47], s66 offen
    buffer_store_dwordx4 v[52:55], v2, s[44:47], s66 offen offset:1024
    s_branch L_55
L_54:
    buffer_store_dwordx4 v[48:51], v2, s[44:47], s66 offen sc1
    buffer_store_dwordx4 v[52:55], v2, s[44:47], s66 offen offset:1024 sc1
L_55:
    s_sleep 5
    s_xor_b32 s62, s66, 0x4000
    s_xor_b32 s63, s66, 0x8000
    s_xor_b32 s3, s66, 0xc000
    v_bfe_u32 v13, v1, 3, 2
    v_cmp_eq_u32 vcc, s56, v13
    v_mov_b32 v13, 0x7ffffff0
    s_nop 0
    v_cndmask_b32 v13, v13, v2, vcc
    v_pk_fma_f32 v[16:17], v[32:33], 0.5, v[16:17] op_sel_hi:[1,0,1]
    v_pk_fma_f32 v[18:19], v[34:35], 0.5, v[18:19] op_sel_hi:[1,0,1]
    v_pk_fma_f32 v[20:21], v[36:37], 0.5, v[20:21] op_sel_hi:[1,0,1]
    v_pk_fma_f32 v[22:23], v[38:39], 0.5, v[22:23] op_sel_hi:[1,0,1]
    v_pk_fma_f32 v[24:25], v[40:41], 0.5, v[24:25] op_sel_hi:[1,0,1]
    v_pk_fma_f32 v[26:27], v[42:43], 0.5, v[26:27] op_sel_hi:[1,0,1]
    v_pk_fma_f32 v[28:29], v[44:45], 0.5, v[28:29] op_sel_hi:[1,0,1]
    v_pk_fma_f32 v[30:31], v[46:47], 0.5, v[30:31] op_sel_hi:[1,0,1]
    v_mov_b32 v14, 0x3f00
    v_mov_b32 v15, 0.5
    s_movk_i32 s4, 0x4000
    s_nop 1
P_56:
    buffer_load_dwordx4 v[128:131], v13, s[44:47], s62 offen offset:0 sc1
    buffer_load_dwordx4 v[132:135], v13, s[44:47], s62 offen offset:1024 sc1
    buffer_load_dwordx4 v[136:139], v13, s[44:47], s63 offen offset:0 sc1
    buffer_load_dwordx4 v[140:143], v13, s[44:47], s63 offen offset:1024 sc1
    buffer_load_dwordx4 v[144:147], v13, s[44:47], s3 offen offset:0 sc1
    buffer_load_dwordx4 v[148:151], v13, s[44:47], s3 offen offset:1024 sc1
    s_waitcnt vmcnt(0)
    v_max_u32 v12, v128, v129
    v_max3_u32 v12, v12, v130, v131
    v_max3_u32 v12, v12, v132, v133
    v_max3_u32 v12, v12, v134, v135
    v_max3_u32 v12, v12, v136, v137
    v_max3_u32 v12, v12, v138, v139
    v_max3_u32 v12, v12, v140, v141
    v_max3_u32 v12, v12, v142, v143
    v_max3_u32 v12, v12, v144, v145
    v_max3_u32 v12, v12, v146, v147
    v_max3_u32 v12, v12, v148, v149
    v_max3_u32 v12, v12, v150, v151
    v_cmp_eq_u32 vcc, -1, v12
    s_nop 1
    s_cbranch_vccz D_57
    s_sleep 1
    s_sub_u32 s4, s4, 1
    s_cbranch_scc0 P_56
D_57:
    s_nop 1
    v_dot2c_f32_bf16 v16, v128, v14
    v_dot2c_f32_bf16 v17, v128, v15
    v_dot2c_f32_bf16 v18, v129, v14
    v_dot2c_f32_bf16 v19, v129, v15
    v_dot2c_f32_bf16 v20, v130, v14
    v_dot2c_f32_bf16 v21, v130, v15
    v_dot2c_f32_bf16 v22, v131, v14
    v_dot2c_f32_bf16 v23, v131, v15
    v_dot2c_f32_bf16 v24, v132, v14
    v_dot2c_f32_bf16 v25, v132, v15
    v_dot2c_f32_bf16 v26, v133, v14
    v_dot2c_f32_bf16 v27, v133, v15
    v_dot2c_f32_bf16 v28, v134, v14
    v_dot2c_f32_bf16 v29, v134, v15
    v_dot2c_f32_bf16 v30, v135, v14
    v_dot2c_f32_bf16 v31, v135, v15
    v_dot2c_f32_bf16 v16, v136, v14
    v_dot2c_f32_bf16 v17, v136, v15
    v_dot2c_f32_bf16 v18, v137, v14
    v_dot2c_f32_bf16 v19, v137, v15
    v_dot2c_f32_bf16 v20, v138, v14
    v_dot2c_f32_bf16 v21, v138, v15
    v_dot2c_f32_bf16 v22, v139, v14
    v_dot2c_f32_bf16 v23, v139, v15
    v_dot2c_f32_bf16 v24, v140, v14
    v_dot2c_f32_bf16 v25, v140, v15
    v_dot2c_f32_bf16 v26, v141, v14
    v_dot2c_f32_bf16 v27, v141, v15
    v_dot2c_f32_bf16 v28, v142, v14
    v_dot2c_f32_bf16 v29, v142, v15
    v_dot2c_f32_bf16 v30, v143, v14
    v_dot2c_f32_bf16 v31, v143, v15
    v_dot2c_f32_bf16 v16, v144, v14
    v_dot2c_f32_bf16 v17, v144, v15
    v_dot2c_f32_bf16 v18, v145, v14
    v_dot2c_f32_bf16 v19, v145, v15
    v_dot2c_f32_bf16 v20, v146, v14
    v_dot2c_f32_bf16 v21, v146, v15
    v_dot2c_f32_bf16 v22, v147, v14
    v_dot2c_f32_bf16 v23, v147, v15
    v_dot2c_f32_bf16 v24, v148, v14
    v_dot2c_f32_bf16 v25, v148, v15
    v_dot2c_f32_bf16 v26, v149, v14
    v_dot2c_f32_bf16 v27, v149, v15
    v_dot2c_f32_bf16 v28, v150, v14
    v_dot2c_f32_bf16 v29, v150, v15
    v_dot2c_f32_bf16 v30, v151, v14
    v_dot2c_f32_bf16 v31, v151, v15
    v_add_u32 v9, -16384, v9
    v_add_u32 v10, -16384, v10
    v_pk_mul_f32 v[48:49], v[16:17], v[16:17]
    v_pk_add_f32 v[50:51], v[16:17], v[18:19]
    v_pk_fma_f32 v[48:49], v[18:19], v[18:19], v[48:49]
    v_pk_fma_f32 v[48:49], v[20:21], v[20:21], v[48:49]
    v_pk_fma_f32 v[48:49], v[22:23], v[22:23], v[48:49]
    v_pk_fma_f32 v[48:49], v[24:25], v[24:25], v[48:49]
    v_pk_fma_f32 v[48:49], v[26:27], v[26:27], v[48:49]
    v_pk_fma_f32 v[48:49], v[28:29], v[28:29], v[48:49]
    v_pk_fma_f32 v[48:49], v[30:31], v[30:31], v[48:49]
    v_pk_add_f32 v[50:51], v[50:51], v[20:21]
    v_pk_add_f32 v[50:51], v[50:51], v[22:23]
    v_pk_add_f32 v[50:51], v[50:51], v[24:25]
    v_pk_add_f32 v[50:51], v[50:51], v[26:27]
    v_pk_add_f32 v[50:51], v[50:51], v[28:29]
    v_pk_add_f32 v[50:51], v[50:51], v[30:31]
    v_add_f32 v13, v48, v49
    v_add_f32 v12, v50, v51
    s_nop 1
    v_permlane32_swap_b32 v12, v13
    v_add_f32 v12, v12, v13
    ds_write_b32 v9, v12
    s_waitcnt lgkmcnt(0)
    s_barrier
    ds_read2st64_b32 v[48:49], v10 offset0:0 offset1:1
    ds_read2st64_b32 v[50:51], v10 offset0:2 offset1:3
    ds_read2st64_b32 v[52:53], v10 offset0:4 offset1:5
    ds_read2st64_b32 v[54:55], v10 offset0:6 offset1:7
    s_waitcnt lgkmcnt(0)
    v_pk_add_f32 v[48:49], v[48:49], v[50:51]
    v_pk_add_f32 v[52:53], v[52:53], v[54:55]
    v_pk_add_f32 v[48:49], v[48:49], v[52:53]
    v_add_f32 v12, v48, v49
    v_mul_f32 v12, 0x3b800000, v12
    v_mov_b32 v13, v12
    s_nop 1
    v_permlane32_swap_b32 v12, v13
    v_fma_f32 v13, -v12, v12, v13
    v_max_f32 v13, 0, v13
    v_add_f32 v13, 0x3727c5ac, v13
    v_rsq_f32 v14, v13
    s_nop 0
    v_mul_f32_e64 v15, -v12, v14
    v_pk_fma_f32 v[48:49], v[16:17], v[14:15], v[14:15] op_sel:[0,0,1] op_sel_hi:[1,0,1]
    v_pk_fma_f32 v[50:51], v[18:19], v[14:15], v[14:15] op_sel:[0,0,1] op_sel_hi:[1,0,1]
    v_pk_fma_f32 v[52:53], v[20:21], v[14:15], v[14:15] op_sel:[0,0,1] op_sel_hi:[1,0,1]
    v_pk_fma_f32 v[54:55], v[22:23], v[14:15], v[14:15] op_sel:[0,0,1] op_sel_hi:[1,0,1]
    v_pk_fma_f32 v[56:57], v[24:25], v[14:15], v[14:15] op_sel:[0,0,1] op_sel_hi:[1,0,1]
    v_pk_fma_f32 v[58:59], v[26:27], v[14:15], v[14:15] op_sel:[0,0,1] op_sel_hi:[1,0,1]
    v_pk_fma_f32 v[60:61], v[28:29], v[14:15], v[14:15] op_sel:[0,0,1] op_sel_hi:[1,0,1]
    v_pk_fma_f32 v[62:63], v[30:31], v[14:15], v[14:15] op_sel:[0,0,1] op_sel_hi:[1,0,1]
    v_cvt_pk_bf16_f32 v48, v48, v49
    v_cvt_pk_bf16_f32 v49, v50, v51
    v_cvt_pk_bf16_f32 v50, v52, v53
    v_cvt_pk_bf16_f32 v51, v54, v55
    v_cvt_pk_bf16_f32 v52, v56, v57
    v_cvt_pk_bf16_f32 v53, v58, v59
    v_cvt_pk_bf16_f32 v54, v60, v61
    v_cvt_pk_bf16_f32 v55, v62, v63
    v_bfe_u32 v13, v1, 3, 2
    v_cmp_eq_u32 vcc, s56, v13
    v_mov_b32 v13, 0x7ffffff0
    s_nop 0
    v_cndmask_b32 v13, v13, v11, vcc
    s_lshl_b32 s3, s59, 14
    v_permlane32_swap_b32 v48, v50
    v_permlane32_swap_b32 v49, v51
    buffer_store_dwordx4 v[48:51], v13, s[40:43], s3 offen offset:0
    v_permlane32_swap_b32 v52, v54
    v_permlane32_swap_b32 v53, v55
    buffer_store_dwordx4 v[52:55], v13, s[40:43], s3 offen offset:32
L_end:
    s_endpgm
.section .rodata,"a"
.p2align 6
.amdhsa_kernel standalone__conformer_family_zipformer__speech_kernel
  .amdhsa_next_free_vgpr 256
  .amdhsa_next_free_sgpr 102
  .amdhsa_accum_offset 256
  .amdhsa_group_segment_fixed_size 0
  .amdhsa_kernarg_size 104
  .amdhsa_user_sgpr_count 2
  .amdhsa_user_sgpr_kernarg_segment_ptr 1
  .amdhsa_system_sgpr_workgroup_id_x 1
.end_amdhsa_kernel
```
